```python
import torch

def _softmax(x, axis=-1):
    return torch.softmax(x, dim=axis)
def _gelu(x):
    return torch.nn.functional.gelu(x, approximate="tanh")
def _silu(x):
    return torch.nn.functional.silu(x)
def _sigmoid(x):
    return torch.sigmoid(x)
def _layernorm(x, axis=-1, eps=1e-5):
    m = x.mean(dim=axis, keepdim=True)
    v = x.var(dim=axis, keepdim=True, unbiased=False)
    return (x - m) / torch.sqrt(v + eps)
def _scatter_add(tgt, idx, src, axis=0):
    return tgt.clone().index_add_(axis, idx, src)
def _segment_sum(src, seg, n):
    out = torch.zeros((n,) + src.shape[1:], dtype=src.dtype)
    return out.index_add_(0, seg, src)
def _pad(x, pw):
    flat = tuple(v for pair in reversed(pw) for v in pair)
    return torch.nn.functional.pad(x, flat)

kernel_name = 'gated_mix__sliding_local_dilated__spectral_fnet__prompt'

def setup_inputs():

    _w = (lambda a: (lambda t: t.to(torch.bfloat16) if t.is_floating_point() else t)(torch.as_tensor(a)))
    def _A_setup():
        B, S, D = 1, 2048, 640
        return {
            "x": _w((lambda *s: torch.randn(*s, dtype=torch.bfloat16) * 0.05)(B, S, D)),
            "wqkv": _w((lambda *s: torch.randn(*s, dtype=torch.bfloat16) * 1.6)(D, 3 * D)),
            "wo": _w((lambda *s: torch.randn(*s, dtype=torch.bfloat16) * 0.2)(D, D)),
        }
    _A_in = _A_setup()

    def _B_setup():
        B, S, D = 1, 2048, 640
        ns = torch.arange(S)[:, None] * torch.arange(S)[None, :]
        nd = torch.arange(D)[:, None] * torch.arange(D)[None, :]
        Ws_re = torch.cos(-2.0 * torch.pi * ns / S).to(float)
        Ws_im = torch.sin(-2.0 * torch.pi * ns / S).to(float)
        Wd_re = torch.cos(-2.0 * torch.pi * nd / D).to(float)
        Wd_im = torch.sin(-2.0 * torch.pi * nd / D).to(float)
        return {
            "x": _w((lambda *s: torch.randn(*s, dtype=torch.bfloat16) * 0.05)(B, S, D)),
            "dft_seq_re": _w(Ws_re),
            "dft_seq_im": _w(Ws_im),
            "dft_hid_re": _w(Wd_re),
            "dft_hid_im": _w(Wd_im),
        }
    _B_in = _B_setup()

    return {
        "A_x": _A_in["x"],
        "A_wqkv": _A_in["wqkv"],
        "A_wo": _A_in["wo"],
        "B_x": _B_in["x"],
        "B_dft_seq_re": _B_in["dft_seq_re"],
        "B_dft_seq_im": _B_in["dft_seq_im"],
        "B_dft_hid_re": _B_in["dft_hid_re"],
        "B_dft_hid_im": _B_in["dft_hid_im"],
        "gate_w": _w((lambda *s: torch.randn(*s, dtype=torch.bfloat16) * 0.05)(640) * 16.0),
    }

def reference(A_x, A_wqkv, A_wo, B_x, B_dft_seq_re, B_dft_seq_im, B_dft_hid_re, B_dft_hid_im, gate_w):
    def _A_ref(x, wqkv, wo):
        B, S, D = x.shape
        H = 32; Dh = D // H
        W, dil = 8, 2
        qkv = (lambda x, *d: x.permute(*d))((x @ wqkv).reshape(B, S, 3, H, Dh), 2, 0, 3, 1, 4)
        q, k, v = qkv[0], qkv[1], qkv[2]
        scale = Dh ** -0.5
        pos = torch.arange(S)
        off = torch.arange(W) * dil
        idx = pos[:, None] - off[None, :]
        mask = idx >= 0
        idx_c = torch.where(mask, idx, 0).reshape(-1)
        kg = k[:, :, idx_c, :].reshape(B, H, S, W, Dh)
        vg = v[:, :, idx_c, :].reshape(B, H, S, W, Dh)
        logits = torch.einsum("bhsd,bhswd->bhsw", q, kg) * scale
        logits = torch.where(mask[None, None, :, :], logits, -1e9)
        attn = _softmax(logits, axis=-1)
        o = torch.einsum("bhsw,bhswd->bhsd", attn, vg)
        return (lambda x, *d: x.permute(*d))(o, 0, 2, 1, 3).reshape(B, S, D) @ wo

    def _B_ref(x, dft_seq_re, dft_seq_im, dft_hid_re, dft_hid_im):
        a = torch.einsum("bsd,ed->bse", x, dft_hid_re)
        b = torch.einsum("bsd,ed->bse", x, dft_hid_im)
        y = torch.einsum("ts,bse->bte", dft_seq_re, a) - torch.einsum("ts,bse->bte", dft_seq_im, b)
        return y

    x = A_x
    g = _sigmoid((x * gate_w).sum(-1, keepdims=True))
    a = _A_ref(x, A_wqkv, A_wo)
    b = _B_ref(x, B_dft_seq_re, B_dft_seq_im, B_dft_hid_re, B_dft_hid_im)
    return g * a + (1 - g) * b
```

```asm
; @launch grid=(256,1,1) block=(512,1,1) lds=163840
.amdgcn_target "amdgcn-amd-amdhsa--gfx950"
.text
.globl gated_mix__sliding_local_dilated__spectral_fnet__prompt_kernel
.p2align 8
.type gated_mix__sliding_local_dilated__spectral_fnet__prompt_kernel,@function
gated_mix__sliding_local_dilated__spectral_fnet__prompt_kernel:
    s_load_dwordx4 s[4:7], s[0:1], 0
    s_load_dwordx2 s[8:9], s[0:1], 16
    s_load_dwordx8 s[44:51], s[0:1], 64
    s_cmpk_ge_u32 s2, 256
    s_cbranch_scc1 L_exit
    v_lshrrev_b32 v1, 6, v0
    v_and_b32 v0, 63, v0
    v_readfirstlane_b32 s24, v1
    s_and_b32 s25, s2, 7
    s_lshr_b32 s26, s2, 3
    s_mov_b32 s19, 0x20000
    s_cmp_lt_u32 s24, 4
    s_cbranch_scc1 L_padc
    s_sub_u32 s60, s24, 4
    s_cmp_ge_u32 s26, 20
    s_cbranch_scc1 L_padn
    s_bfe_u32 s55, s25, 0x10001
    s_mulk_i32 s55, 20
    s_add_u32 s55, s55, s26
    s_cmp_eq_u32 s24, 7
    s_cbranch_scc1 L_padx
    s_and_b32 s53, s55, 3
    s_and_b32 s54, s25, 1
    s_lshl2_add_u32 s54, s54, s53
    s_mulk_i32 s54, 160
    v_mul_u32_u24 v2, 6554, v0
    s_movk_i32 s61, 128
    v_add_lshl_u32 v3, v0, s61, 4
    s_movk_i32 s61, -11680
    s_movk_i32 s67, 15360
    s_movk_i32 s64, 3840
    s_mulk_i32 s53, 13108
    s_addk_i32 s53, 13104
    v_lshrrev_b32 v4, 16, v2
    v_add_u32 v5, s53, v2
    v_lshrrev_b32 v5, 16, v5
    v_and_b32 v6, 12, v4
    v_mad_i32_i24 v10, v4, s61, v3
    v_mad_i32_i24 v10, v5, s67, v10
    v_mad_u32_u24 v10, v6, s64, v10
    v_add_u32 v2, 419456, v2
    v_lshrrev_b32 v4, 16, v2
    v_add_u32 v5, s53, v2
    v_lshrrev_b32 v5, 16, v5
    v_and_b32 v6, 12, v4
    v_mad_i32_i24 v11, v4, s61, v3
    v_mad_i32_i24 v11, v5, s67, v11
    v_mad_u32_u24 v11, v6, s64, v11
    v_add_u32 v2, 419456, v2
    s_movk_i32 s61, -160
    v_lshrrev_b32 v4, 16, v2
    v_add_u32 v5, s53, v2
    v_lshrrev_b32 v5, 16, v5
    v_and_b32 v6, 12, v4
    v_mad_i32_i24 v12, v4, s61, v3
    v_sub_u32 v5, v5, v4
    v_lshrrev_b32 v7, 4, v4
    v_xor_b32 v5, v5, v7
    v_and_b32 v7, 15, v4
    v_add_u32 v6, v6, v7
    v_mad_i32_i24 v12, v5, s67, v12
    v_mad_u32_u24 v12, v6, s64, v12
    v_add_u32 v2, 419456, v2
    v_subrev_u32 v3, 46080, v3
    s_movk_i32 s61, 19040
    s_movk_i32 s67, -15360
    v_lshrrev_b32 v4, 16, v2
    v_add_u32 v5, s53, v2
    v_lshrrev_b32 v5, 16, v5
    v_and_b32 v6, 12, v4
    v_mad_i32_i24 v13, v4, s61, v3
    v_mad_i32_i24 v13, v5, s67, v13
    v_mad_u32_u24 v13, v6, s64, v13
    v_add_u32 v2, 419456, v2
    v_add_u32 v3, 4096, v3
    v_lshrrev_b32 v4, 16, v2
    v_add_u32 v5, s53, v2
    v_lshrrev_b32 v5, 16, v5
    v_and_b32 v6, 12, v4
    v_mad_i32_i24 v14, v4, s61, v3
    v_mad_i32_i24 v14, v5, s67, v14
    v_mad_u32_u24 v14, v6, s64, v14
    s_mul_i32 s62, s60, 1280
    s_add_u32 s62, s62, s54
    s_mul_i32 s65, s60, 5120
    s_mov_b32 s18, 2459648
    s_waitcnt lgkmcnt(0)
    s_sub_u32 s16, s6, 2048
    s_subb_u32 s17, s7, 0
    s_add_u32 m0, s65, 0
    s_nop 0
    buffer_load_dwordx4 v10, s[16:19], s62 offen   lds
    buffer_load_dwordx4 v11, s[16:19], s62 offen offset:1024  lds
    buffer_load_dwordx4 v12, s[16:19], s62 offen offset:2048  lds
    buffer_load_dwordx4 v13, s[16:19], s62 offen offset:3072  lds
    s_addk_i32 m0, 4096
    s_nop 0
    buffer_load_dwordx4 v14, s[16:19], s62 offen   lds
    s_add_u32 s62, s62, 122880
    s_branch L_qw
L_padx:
    v_and_b32 v3, 7, v0
    v_lshrrev_b32 v4, 4, v0
    v_xor_b32 v3, v3, v4
    v_lshrrev_b32 v2, 3, v0
    v_mul_u32_u24 v2, 2560, v2
    v_lshl_add_u32 v10, v3, 4, v2
    v_xor_b32 v11, 64, v10
    v_add_u32 v11, 19456, v11
    s_lshr_b32 s56, s55, 2
    s_mul_i32 s57, s56, 204
    s_min_u32 s57, s57, 1824
    s_lshr_b32 s58, s25, 2
    s_add_u32 s57, s57, s58
    s_mulk_i32 s57, 1280
    s_mov_b32 s18, 2621440
    s_mov_b32 m0, 102400
    s_mov_b32 s62, s57
    s_waitcnt lgkmcnt(0)
    s_mov_b64 s[16:17], s[4:5]
L_padxl:
    buffer_load_dwordx4 v10, s[16:19], s62 offen lds
    buffer_load_dwordx4 v11, s[16:19], s62 offen offset:1024 lds
    s_addk_i32 m0, 2048
    s_add_u32 s62, s62, 40960
    s_cmp_lt_u32 m0, 116736
    s_cbranch_scc1 L_padxl
    s_branch L_qx
L_padn:
    s_sub_u32 s52, s26, 20
    s_cmp_lg_u32 s24, 4
    s_cbranch_scc1 L_padw
    s_bfe_u32 s68, s25, 0x10001
    s_mulk_i32 s68, 1020
    s_mul_i32 s69, s52, 88
    s_add_u32 s68, s68, s69
    s_lshr_b32 s69, s25, 2
    s_add_u32 s68, s68, s69
    s_mulk_i32 s68, 1280
    s_movk_i32 s69, 128
    v_mul_u32_u24 v14, 2560, v0
    s_movk_i32 s64, 44
    s_mov_b32 s18, 2621440
    s_waitcnt lgkmcnt(0)
    s_mov_b64 s[16:17], s[4:5]
    s_branch L_padd
L_padw:
    s_lshl1_add_u32 s68, s52, s60
    s_mulk_i32 s68, 40
    s_sub_u32 s68, s68, 40
    v_add_u32 v14, s68, v0
    v_mul_u32_u24 v15, 13108, v14
    v_lshrrev_b32 v15, 16, v15
    v_mul_u32_u24 v15, 5, v15
    v_add_lshl_u32 v14, v14, v15, 7
    s_and_b32 s68, s25, 1
    s_mulk_i32 s68, 640
    s_mov_b32 s69, 245760
    s_cmp_eq_u32 s24, 7
    s_cselect_b32 s64, 0, 40
    s_mov_b32 s18, 2457600
    s_waitcnt lgkmcnt(0)
    s_mov_b64 s[16:17], s[6:7]
L_padd:
    v_cmp_gt_u32 vcc, s64, v0
    v_bfrev_b32 v15, 1
    s_nop 0
    v_cndmask_b32 v14, v15, v14, vcc
    buffer_load_dword v15, v14, s[16:19], s68 offen
    s_add_u32 s68, s68, s69
    buffer_load_dword v15, v14, s[16:19], s68 offen
    s_add_u32 s68, s68, s69
    buffer_load_dword v15, v14, s[16:19], s68 offen
    s_add_u32 s68, s68, s69
    s_cmp_lt_u32 s52, 6
    s_cbranch_scc1 L_fl
    s_branch L_pl
L_padc:
    s_cmp_lg_u32 s24, 0
    s_cbranch_scc1 L_padc2
    s_getpc_b64 s[16:17]
L_pc:
    s_mov_b32 s18, L_code_hot-L_pc
    s_mul_i32 s60, s26, 1408
    v_lshlrev_b32 v2, 7, v0
    s_mov_b64 exec, 0x7ff
    buffer_load_dword v255, v2, s[16:19], s60 offen
    s_mov_b64 exec, -1
L_padc2:
    s_cmp_lt_u32 s26, 20
    s_cbranch_scc1 L_qc
    s_cmp_lt_u32 s26, 26
    s_cbranch_scc1 L_fc
    s_branch L_hc0
L_padend:
L_qw:
    s_lshr_b32 s56, s55, 2
    s_mul_i32 s57, s56, 204
    s_min_u32 s57, s57, 1824
    s_lshr_b32 s58, s25, 2
    s_add_u32 s57, s57, s58
    s_mulk_i32 s57, 1280
    s_movk_i32 s64, 109
    s_cmp_eq_u32 s56, 8
    s_cselect_b32 s64, 103, s64
    s_cmp_eq_u32 s56, 9
    s_cselect_b32 s64, 112, s64
    s_mulk_i32 s64, 2560
    s_add_u32 s64, s64, s57
    s_min_u32 s64, s64, 2621440
    s_cmp_eq_u32 s56, 0
    s_cselect_b32 s61, 0, 7
    s_mul_i32 s72, s60, 6
    s_add_u32 s61, s61, s72
    s_mul_i32 s68, s61, 2560
    s_add_u32 s68, s68, s57
    s_add_u32 s68, s68, s54
    s_mov_b32 s22, s64
    s_mov_b32 s23, 0x20000
    v_mul_u32_u24 v30, 6554, v0
    v_lshrrev_b32 v30, 16, v30
    v_lshlrev_b32 v31, 4, v0
    v_mul_u32_u24 v38, 2400, v30
    v_add_u32 v38, v38, v31
    s_mov_b64 s[20:21], s[50:51]
    s_mulk_i32 s61, 176
    s_add_u32 s61, s61, 144128
    v_lshl_add_u32 v37, v30, 4, v31
    v_add_u32 v37, s61, v37
    s_call_b64 s[70:71], S_ldsetup
    s_add_u32 m0, s65, 15360
    s_nop 0
    buffer_load_dwordx4 v10, s[16:19], s62 offen   lds
    buffer_load_dwordx4 v11, s[16:19], s62 offen offset:1024  lds
    buffer_load_dwordx4 v12, s[16:19], s62 offen offset:2048  lds
    buffer_load_dwordx4 v13, s[16:19], s62 offen offset:3072  lds
    s_addk_i32 m0, 4096
    s_nop 0
    buffer_load_dwordx4 v14, s[16:19], s62 offen   lds
    s_add_u32 s62, s62, 122880
    s_waitcnt vmcnt(5)
    s_barrier
    s_add_u32 m0, s65, 30720
    s_nop 0
    buffer_load_dwordx4 v10, s[16:19], s62 offen   lds
    buffer_load_dwordx4 v11, s[16:19], s62 offen offset:1024  lds
    buffer_load_dwordx4 v12, s[16:19], s62 offen offset:2048  lds
    buffer_load_dwordx4 v13, s[16:19], s62 offen offset:3072  lds
    s_addk_i32 m0, 4096
    s_nop 0
    buffer_load_dwordx4 v14, s[16:19], s62 offen   lds
    s_add_u32 s62, s62, 122880
    s_waitcnt vmcnt(5)
    s_barrier
    s_add_u32 m0, s65, 46080
    s_nop 0
    buffer_load_dwordx4 v10, s[16:19], s62 offen   lds
    buffer_load_dwordx4 v11, s[16:19], s62 offen offset:1024  lds
    buffer_load_dwordx4 v12, s[16:19], s62 offen offset:2048  lds
    buffer_load_dwordx4 v13, s[16:19], s62 offen offset:3072  lds
    s_addk_i32 m0, 4096
    s_nop 0
    buffer_load_dwordx4 v14, s[16:19], s62 offen   lds
    s_add_u32 s62, s62, 122880
    s_waitcnt vmcnt(5)
    s_barrier
    s_add_u32 m0, s65, 0
    s_nop 0
    buffer_load_dwordx4 v10, s[16:19], s62 offen   lds
    buffer_load_dwordx4 v11, s[16:19], s62 offen offset:1024  lds
    buffer_load_dwordx4 v12, s[16:19], s62 offen offset:2048  lds
    buffer_load_dwordx4 v13, s[16:19], s62 offen offset:3072  lds
    s_addk_i32 m0, 4096
    s_nop 0
    buffer_load_dwordx4 v14, s[16:19], s62 offen   lds
    s_add_u32 s62, s62, 122880
    s_waitcnt vmcnt(5)
    s_barrier
    s_add_u32 m0, s65, 15360
    s_nop 0
    buffer_load_dwordx4 v10, s[16:19], s62 offen   lds
    buffer_load_dwordx4 v11, s[16:19], s62 offen offset:1024  lds
    buffer_load_dwordx4 v12, s[16:19], s62 offen offset:2048  lds
    buffer_load_dwordx4 v13, s[16:19], s62 offen offset:3072  lds
    s_addk_i32 m0, 4096
    s_nop 0
    buffer_load_dwordx4 v14, s[16:19], s62 offen   lds
    s_add_u32 s62, s62, 122880
    s_waitcnt vmcnt(5)
    s_barrier
    s_add_u32 m0, s65, 30720
    s_nop 0
    buffer_load_dwordx4 v10, s[16:19], s62 offen   lds
    buffer_load_dwordx4 v11, s[16:19], s62 offen offset:1024  lds
    buffer_load_dwordx4 v12, s[16:19], s62 offen offset:2048  lds
    buffer_load_dwordx4 v13, s[16:19], s62 offen offset:3072  lds
    s_addk_i32 m0, 4096
    s_nop 0
    buffer_load_dwordx4 v14, s[16:19], s62 offen   lds
    s_add_u32 s62, s62, 122880
    s_waitcnt vmcnt(5)
    s_barrier
    s_add_u32 m0, s65, 46080
    s_nop 0
    buffer_load_dwordx4 v10, s[16:19], s62 offen   lds
    buffer_load_dwordx4 v11, s[16:19], s62 offen offset:1024  lds
    buffer_load_dwordx4 v12, s[16:19], s62 offen offset:2048  lds
    buffer_load_dwordx4 v13, s[16:19], s62 offen offset:3072  lds
    s_addk_i32 m0, 4096
    s_nop 0
    buffer_load_dwordx4 v14, s[16:19], s62 offen   lds
    s_add_u32 s62, s62, 122880
    s_waitcnt vmcnt(5)
    s_barrier
    s_add_u32 m0, s65, 0
    s_nop 0
    buffer_load_dwordx4 v10, s[16:19], s62 offen   lds
    buffer_load_dwordx4 v11, s[16:19], s62 offen offset:1024  lds
    buffer_load_dwordx4 v12, s[16:19], s62 offen offset:2048  lds
    buffer_load_dwordx4 v13, s[16:19], s62 offen offset:3072  lds
    s_addk_i32 m0, 4096
    s_nop 0
    buffer_load_dwordx4 v14, s[16:19], s62 offen   lds
    s_add_u32 s62, s62, 122880
    s_call_b64 s[70:71], S_voff0
    s_waitcnt vmcnt(5)
    s_barrier
    s_add_u32 m0, s65, 15360
    s_nop 0
    buffer_load_dwordx4 v10, s[16:19], s62 offen   lds
    buffer_load_dwordx4 v11, s[16:19], s62 offen offset:1024  lds
    buffer_load_dwordx4 v12, s[16:19], s62 offen offset:2048  lds
    buffer_load_dwordx4 v13, s[16:19], s62 offen offset:3072  lds
    s_addk_i32 m0, 4096
    s_nop 0
    buffer_load_dwordx4 v14, s[16:19], s62 offen   lds
    s_add_u32 s62, s62, 122880
    s_waitcnt vmcnt(5)
    s_barrier
    s_add_u32 m0, s65, 30720
    s_nop 0
    buffer_load_dwordx4 v10, s[16:19], s62 offen   lds
    buffer_load_dwordx4 v11, s[16:19], s62 offen offset:1024  lds
    buffer_load_dwordx4 v12, s[16:19], s62 offen offset:2048  lds
    buffer_load_dwordx4 v13, s[16:19], s62 offen offset:3072  lds
    s_addk_i32 m0, 4096
    s_nop 0
    buffer_load_dwordx4 v14, s[16:19], s62 offen   lds
    s_add_u32 s62, s62, 122880
    s_call_b64 s[70:71], S_voff1
    s_waitcnt vmcnt(5)
    s_barrier
    s_add_u32 m0, s65, 46080
    s_nop 0
    buffer_load_dwordx4 v10, s[16:19], s62 offen   lds
    buffer_load_dwordx4 v11, s[16:19], s62 offen offset:1024  lds
    buffer_load_dwordx4 v12, s[16:19], s62 offen offset:2048  lds
    buffer_load_dwordx4 v13, s[16:19], s62 offen offset:3072  lds
    s_addk_i32 m0, 4096
    s_nop 0
    buffer_load_dwordx4 v14, s[16:19], s62 offen   lds
    s_add_u32 s62, s62, 122880
    s_waitcnt vmcnt(5)
    s_barrier
    s_add_u32 m0, s65, 0
    s_nop 0
    buffer_load_dwordx4 v10, s[16:19], s62 offen   lds
    buffer_load_dwordx4 v11, s[16:19], s62 offen offset:1024  lds
    buffer_load_dwordx4 v12, s[16:19], s62 offen offset:2048  lds
    buffer_load_dwordx4 v13, s[16:19], s62 offen offset:3072  lds
    s_addk_i32 m0, 4096
    s_nop 0
    buffer_load_dwordx4 v14, s[16:19], s62 offen   lds
    s_add_u32 s62, s62, 122880
    s_call_b64 s[70:71], S_voff2
    s_waitcnt vmcnt(5)
    s_barrier
    s_add_u32 m0, s65, 15360
    s_nop 0
    buffer_load_dwordx4 v10, s[16:19], s62 offen   lds
    buffer_load_dwordx4 v11, s[16:19], s62 offen offset:1024  lds
    buffer_load_dwordx4 v12, s[16:19], s62 offen offset:2048  lds
    buffer_load_dwordx4 v13, s[16:19], s62 offen offset:3072  lds
    s_addk_i32 m0, 4096
    s_nop 0
    buffer_load_dwordx4 v14, s[16:19], s62 offen   lds
    s_add_u32 s62, s62, 122880
    s_waitcnt vmcnt(5)
    s_barrier
    s_add_u32 m0, s65, 30720
    s_nop 0
    buffer_load_dwordx4 v10, s[16:19], s62 offen   lds
    buffer_load_dwordx4 v11, s[16:19], s62 offen offset:1024  lds
    buffer_load_dwordx4 v12, s[16:19], s62 offen offset:2048  lds
    buffer_load_dwordx4 v13, s[16:19], s62 offen offset:3072  lds
    s_addk_i32 m0, 4096
    s_nop 0
    buffer_load_dwordx4 v14, s[16:19], s62 offen   lds
    s_add_u32 s62, s62, 122880
    s_call_b64 s[70:71], S_voff3
    s_waitcnt vmcnt(5)
    s_barrier
    s_add_u32 m0, s65, 46080
    s_nop 0
    buffer_load_dwordx4 v10, s[16:19], s62 offen   lds
    buffer_load_dwordx4 v11, s[16:19], s62 offen offset:1024  lds
    buffer_load_dwordx4 v12, s[16:19], s62 offen offset:2048  lds
    buffer_load_dwordx4 v13, s[16:19], s62 offen offset:3072  lds
    s_addk_i32 m0, 4096
    s_nop 0
    buffer_load_dwordx4 v14, s[16:19], s62 offen   lds
    s_add_u32 s62, s62, 122880
    s_waitcnt vmcnt(5)
    s_barrier
    s_add_u32 m0, s65, 0
    s_nop 0
    buffer_load_dwordx4 v10, s[16:19], s62 offen   lds
    buffer_load_dwordx4 v11, s[16:19], s62 offen offset:1024  lds
    buffer_load_dwordx4 v12, s[16:19], s62 offen offset:2048  lds
    buffer_load_dwordx4 v13, s[16:19], s62 offen offset:3072  lds
    s_addk_i32 m0, 4096
    s_nop 0
    buffer_load_dwordx4 v14, s[16:19], s62 offen   lds
    s_add_u32 s62, s62, 122880
    s_call_b64 s[70:71], S_voff4
    s_waitcnt vmcnt(5)
    s_barrier
    s_add_u32 m0, s65, 15360
    s_nop 0
    buffer_load_dwordx4 v10, s[16:19], s62 offen   lds
    buffer_load_dwordx4 v11, s[16:19], s62 offen offset:1024  lds
    buffer_load_dwordx4 v12, s[16:19], s62 offen offset:2048  lds
    buffer_load_dwordx4 v13, s[16:19], s62 offen offset:3072  lds
    s_addk_i32 m0, 4096
    s_nop 0
    buffer_load_dwordx4 v14, s[16:19], s62 offen   lds
    s_add_u32 s62, s62, 122880
    s_waitcnt vmcnt(5)
    s_barrier
    s_add_u32 m0, s65, 30720
    s_nop 0
    buffer_load_dwordx4 v10, s[16:19], s62 offen   lds
    buffer_load_dwordx4 v11, s[16:19], s62 offen offset:1024  lds
    buffer_load_dwordx4 v12, s[16:19], s62 offen offset:2048  lds
    buffer_load_dwordx4 v13, s[16:19], s62 offen offset:3072  lds
    s_addk_i32 m0, 4096
    s_nop 0
    buffer_load_dwordx4 v14, s[16:19], s62 offen   lds
    s_add_u32 s62, s62, 122880
    s_call_b64 s[70:71], S_voff5
    s_waitcnt vmcnt(5)
    s_barrier
    s_add_u32 m0, s65, 46080
    s_nop 0
    buffer_load_dwordx4 v10, s[16:19], s62 offen   lds
    buffer_load_dwordx4 v11, s[16:19], s62 offen offset:1024  lds
    buffer_load_dwordx4 v12, s[16:19], s62 offen offset:2048  lds
    buffer_load_dwordx4 v13, s[16:19], s62 offen offset:3072  lds
    s_addk_i32 m0, 4096
    s_nop 0
    buffer_load_dwordx4 v14, s[16:19], s62 offen   lds
    s_add_u32 s62, s62, 122880
    s_waitcnt vmcnt(5)
    s_barrier
    s_mov_b32 m0, 61440
    s_mov_b32 s66, 0
    s_call_b64 s[70:71], S_woround
    s_waitcnt vmcnt(5)
    s_barrier
    s_mov_b32 m0, 81920
    s_mov_b32 s66, 20480
    s_call_b64 s[70:71], S_woround
    s_barrier
    s_mov_b32 m0, 0
    s_mov_b32 s66, 40960
    s_call_b64 s[70:71], S_woround
    s_mov_b32 m0, 20480
    s_mov_b32 s66, 61440
    s_call_b64 s[70:71], S_woround
    s_add_u32 s16, s50, 2621440
    s_addc_u32 s17, s51, 0
    s_mov_b32 s18, 2891776
    s_mov_b32 s19, 0x20000
    s_mul_i32 s64, s28, 90112
    s_and_b32 s65, s24, 3
    s_lshl_b32 s63, s65, 6
    s_add_u32 s63, s63, 105472
    s_lshl_b32 s65, s65, 10
    s_add_u32 s65, s65, 143360
    s_mov_b64 s[12:13], s[50:51]
    s_mov_b32 s14, 2621440
    s_mov_b32 s15, 0x20000
    s_mov_b32 m0, s99
    s_mul_i32 s62, s98, 1280
    s_barrier
    s_mov_b32 exec_hi, 0x0fffffff
    s_barrier
    ds_read_b128 v[40:43], v37 offset:0
    ds_read_b128 v[44:47], v37 offset:3168
    ds_read_b128 v[48:51], v37 offset:6336
    s_waitcnt lgkmcnt(2)
    buffer_store_dwordx4 v[40:43], v38, s[20:23], s68 offen sc1
    s_add_u32 s68, s68, 46080
    s_waitcnt lgkmcnt(1)
    buffer_store_dwordx4 v[44:47], v38, s[20:23], s68 offen sc1
    s_add_u32 s68, s68, 46080
    s_waitcnt lgkmcnt(0)
    buffer_store_dwordx4 v[48:51], v38, s[20:23], s68 offen sc1
    s_add_u32 s68, s68, 46080
    s_barrier
    ds_read_b128 v[52:55], v37 offset:9504
    ds_read_b128 v[56:59], v37 offset:12672
    ds_read_b128 v[60:63], v37 offset:15840
    ds_read_b128 v[64:67], v37 offset:19008
    s_waitcnt lgkmcnt(3)
    buffer_store_dwordx4 v[52:55], v38, s[20:23], s68 offen sc1
    s_add_u32 s68, s68, 46080
    s_waitcnt lgkmcnt(2)
    buffer_store_dwordx4 v[56:59], v38, s[20:23], s68 offen sc1
    s_add_u32 s68, s68, 46080
    s_waitcnt lgkmcnt(1)
    buffer_store_dwordx4 v[60:63], v38, s[20:23], s68 offen sc1
    s_add_u32 s68, s68, 46080
    s_waitcnt lgkmcnt(0)
    buffer_store_dwordx4 v[64:67], v38, s[20:23], s68 offen sc1
    s_mov_b32 exec_hi, -1
    s_mov_b32 m0, 40960
    s_mov_b32 s66, 81920
    s_call_b64 s[70:71], S_woround
    s_mov_b32 m0, s99
    s_waitcnt vmcnt(12)
L_ldG:
    s_barrier
    buffer_load_dwordx4 v33, s[12:15], s62 offen  sc1 lds
    buffer_load_dwordx4 v34, s[12:15], s62 offen offset:1024 sc1 lds
    s_addk_i32 m0, 2048
    s_addk_i32 s62, 128
    buffer_load_dwordx4 v33, s[12:15], s62 offen  sc1 lds
    buffer_load_dwordx4 v34, s[12:15], s62 offen offset:1024 sc1 lds
    s_addk_i32 m0, 2048
    s_addk_i32 s62, 128
    buffer_load_dwordx4 v33, s[12:15], s62 offen  sc1 lds
    buffer_load_dwordx4 v34, s[12:15], s62 offen offset:1024 sc1 lds
    s_addk_i32 m0, 2048
    s_addk_i32 s62, 128
    buffer_load_dwordx4 v33, s[12:15], s62 offen  sc1 lds
    buffer_load_dwordx4 v34, s[12:15], s62 offen offset:1024 sc1 lds
    s_addk_i32 m0, 2048
    s_addk_i32 s62, 128
    s_waitcnt vmcnt(6)
    s_barrier
    buffer_load_dwordx4 v33, s[12:15], s62 offen  sc1 lds
    buffer_load_dwordx4 v34, s[12:15], s62 offen offset:1024 sc1 lds
    s_addk_i32 m0, 2048
    s_addk_i32 s62, 128
    s_waitcnt vmcnt(6)
    s_barrier
    s_sub_u32 m0, s99, 40960
    s_nop 0
    buffer_load_dwordx4 v33, s[12:15], s62 offen  sc1 lds
    buffer_load_dwordx4 v34, s[12:15], s62 offen offset:1024 sc1 lds
    s_addk_i32 m0, 2048
    s_addk_i32 s62, 128
    s_load_dword s52, s[30:31], 0 glc
    s_waitcnt vmcnt(6)
    s_barrier
    buffer_load_dwordx4 v33, s[12:15], s62 offen  sc1 lds
    buffer_load_dwordx4 v34, s[12:15], s62 offen offset:1024 sc1 lds
    s_addk_i32 m0, 2048
    s_addk_i32 s62, 128
    s_waitcnt vmcnt(6)
    s_barrier
    buffer_load_dwordx4 v33, s[12:15], s62 offen  sc1 lds
    buffer_load_dwordx4 v34, s[12:15], s62 offen offset:1024 sc1 lds
    s_addk_i32 m0, 2048
    s_addk_i32 s62, 128
    s_waitcnt vmcnt(6)
    s_barrier
    buffer_load_dwordx4 v33, s[12:15], s62 offen  sc1 lds
    buffer_load_dwordx4 v34, s[12:15], s62 offen offset:1024 sc1 lds
    s_addk_i32 m0, 2048
    s_addk_i32 s62, 128
    s_waitcnt vmcnt(6)
    s_barrier
    buffer_load_dwordx4 v33, s[12:15], s62 offen  sc1 lds
    buffer_load_dwordx4 v34, s[12:15], s62 offen offset:1024 sc1 lds
    s_addk_i32 m0, 2048
    s_addk_i32 s62, 128
    s_waitcnt lgkmcnt(0)
    s_cmp_eq_u32 s52, 1
    s_cbranch_scc0 L_ldlate
    s_mov_b32 m0, s63
    s_mov_b64 exec, 0xffff
    buffer_load_dword v75, s[16:19], 0 offen sc1 lds
    s_mov_b64 exec, -1
    s_mov_b32 m0, s65
    s_nop 0
    buffer_load_dwordx4 v70, s[16:19], s64 offen  sc1 lds
    s_addk_i32 m0, 4096
    s_nop 0
    buffer_load_dwordx4 v71, s[16:19], s64 offen  sc1 lds
    s_addk_i32 m0, 4096
    s_waitcnt vmcnt(9)
    s_barrier
    buffer_load_dwordx4 v72, s[16:19], s64 offen  sc1 lds
    s_addk_i32 m0, 4096
    s_nop 0
    buffer_load_dwordx4 v73, s[16:19], s64 offen  sc1 lds
    s_addk_i32 m0, 4096
    s_waitcnt vmcnt(9)
    s_barrier
    buffer_load_dwordx4 v74, s[16:19], s64 offen  sc1 lds
    s_addk_i32 m0, 4096
    s_waitcnt vmcnt(8)
    s_barrier
    s_waitcnt vmcnt(6)
    s_barrier
L_ldend:
    s_waitcnt vmcnt(3)
    s_barrier
    s_waitcnt vmcnt(1)
    s_barrier
    s_waitcnt vmcnt(0)
    s_barrier
    s_endpgm
L_ldlate:
    s_waitcnt vmcnt(6)
    s_barrier
    s_waitcnt vmcnt(4)
    s_barrier
    s_waitcnt vmcnt(2)
    s_barrier
    s_waitcnt vmcnt(0)
    s_barrier
    s_mov_b32 s74, 200000
L_sp1:
    s_load_dword s52, s[30:31], 0 glc
    s_sub_u32 s74, s74, 1
    s_cbranch_scc1 L_spe2
    s_waitcnt lgkmcnt(0)
    s_cmp_eq_u32 s52, 1
    s_cbranch_scc0 L_sp1
L_spe2:
    s_mov_b32 m0, s63
    s_mov_b64 exec, 0xffff
    buffer_load_dword v75, s[16:19], 0 offen sc1 lds
    s_mov_b64 exec, -1
    s_mov_b32 m0, s65
    s_nop 0
    buffer_load_dwordx4 v70, s[16:19], s64 offen  sc1 lds
    s_addk_i32 m0, 4096
    s_nop 0
    buffer_load_dwordx4 v71, s[16:19], s64 offen  sc1 lds
    s_addk_i32 m0, 4096
    s_nop 0
    buffer_load_dwordx4 v72, s[16:19], s64 offen  sc1 lds
    s_addk_i32 m0, 4096
    s_nop 0
    buffer_load_dwordx4 v73, s[16:19], s64 offen  sc1 lds
    s_addk_i32 m0, 4096
    s_nop 0
    buffer_load_dwordx4 v74, s[16:19], s64 offen  sc1 lds
    s_addk_i32 m0, 4096
    s_branch L_ldend
L_qx:
    v_add_u32 v9, 1024, v11
    v_add_u32 v23, 243712, v9
    v_add_u32 v22, 244736, v10
    v_add_u32 v21, 204800, v9
    v_add_u32 v20, 201728, v10
    v_add_u32 v19, 161792, v9
    v_add_u32 v18, 162816, v10
    v_add_u32 v17, 122880, v9
    v_add_u32 v16, 120832, v10
    v_add_u32 v15, 80896, v9
    v_add_u32 v14, 81920, v10
    v_add_u32 v13, 37888, v9
    v_add_u32 v12, 38912, v10
    s_movk_i32 s64, 109
    s_cmp_eq_u32 s56, 8
    s_cselect_b32 s64, 103, s64
    s_cmp_eq_u32 s56, 9
    s_cselect_b32 s64, 112, s64
    s_mulk_i32 s64, 2560
    s_add_u32 s64, s64, s57
    s_min_u32 s64, s64, 2621440
    s_mov_b32 s18, s64
    s_add_u32 s62, s57, 128
    s_call_b64 s[70:71], S_ldsetup
    v_lshlrev_b32 v26, 7, v0
    v_mov_b32 v27, 1
    v_mov_b32 v28, 1
    s_and_b32 s100, s25, 1
    s_lshl1_add_u32 s101, s58, s100
    s_lshl_b32 s101, s101, 8
    s_lshl_b32 s60, s58, 13
    s_addk_i32 s60, 8192
    s_lshl2_add_u32 s100, s100, s60
    s_mov_b32 m0, 73728
    s_nop 0
    buffer_load_dwordx4 v10, s[16:19], s62 offen   lds
    buffer_load_dwordx4 v11, s[16:19], s62 offen offset:1024  lds
    buffer_load_dwordx4 v12, s[16:19], s62 offen offset:2048  lds
    buffer_load_dwordx4 v13, s[16:19], s62 offen offset:3072  lds
    s_addk_i32 m0, 4096
    s_nop 0
    buffer_load_dwordx4 v14, s[16:19], s62 offen   lds
    buffer_load_dwordx4 v15, s[16:19], s62 offen offset:1024  lds
    buffer_load_dwordx4 v16, s[16:19], s62 offen offset:2048  lds
    s_waitcnt vmcnt(7) lgkmcnt(0)
    s_barrier
    s_mov_b32 m0, 80896
    s_nop 0
    buffer_load_dwordx4 v17, s[16:19], s62 offen   lds
    buffer_load_dwordx4 v18, s[16:19], s62 offen offset:1024  lds
    buffer_load_dwordx4 v19, s[16:19], s62 offen offset:2048  lds
    buffer_load_dwordx4 v20, s[16:19], s62 offen offset:3072  lds
    s_addk_i32 m0, 4096
    s_nop 0
    buffer_load_dwordx4 v21, s[16:19], s62 offen   lds
    buffer_load_dwordx4 v22, s[16:19], s62 offen offset:1024  lds
    buffer_load_dwordx4 v23, s[16:19], s62 offen offset:2048  lds
    s_addk_i32 s62, 128
    s_barrier
    s_mov_b32 m0, 88064
    s_nop 0
    buffer_load_dwordx4 v10, s[16:19], s62 offen   lds
    buffer_load_dwordx4 v11, s[16:19], s62 offen offset:1024  lds
    buffer_load_dwordx4 v12, s[16:19], s62 offen offset:2048  lds
    buffer_load_dwordx4 v13, s[16:19], s62 offen offset:3072  lds
    s_addk_i32 m0, 4096
    s_nop 0
    buffer_load_dwordx4 v14, s[16:19], s62 offen   lds
    buffer_load_dwordx4 v15, s[16:19], s62 offen offset:1024  lds
    buffer_load_dwordx4 v16, s[16:19], s62 offen offset:2048  lds
    s_waitcnt vmcnt(7)
    s_barrier
    s_mov_b32 m0, 95232
    s_nop 0
    buffer_load_dwordx4 v17, s[16:19], s62 offen   lds
    buffer_load_dwordx4 v18, s[16:19], s62 offen offset:1024  lds
    buffer_load_dwordx4 v19, s[16:19], s62 offen offset:2048  lds
    buffer_load_dwordx4 v20, s[16:19], s62 offen offset:3072  lds
    s_addk_i32 m0, 4096
    s_nop 0
    buffer_load_dwordx4 v21, s[16:19], s62 offen   lds
    buffer_load_dwordx4 v22, s[16:19], s62 offen offset:1024  lds
    buffer_load_dwordx4 v23, s[16:19], s62 offen offset:2048  lds
    s_addk_i32 s62, 128
    s_barrier
    s_mov_b32 m0, 102400
    s_nop 0
    buffer_load_dwordx4 v10, s[16:19], s62 offen   lds
    buffer_load_dwordx4 v11, s[16:19], s62 offen offset:1024  lds
    buffer_load_dwordx4 v12, s[16:19], s62 offen offset:2048  lds
    buffer_load_dwordx4 v13, s[16:19], s62 offen offset:3072  lds
    s_addk_i32 m0, 4096
    s_nop 0
    buffer_load_dwordx4 v14, s[16:19], s62 offen   lds
    buffer_load_dwordx4 v15, s[16:19], s62 offen offset:1024  lds
    buffer_load_dwordx4 v16, s[16:19], s62 offen offset:2048  lds
    s_waitcnt vmcnt(7)
    s_barrier
    s_mov_b32 m0, 109568
    s_nop 0
    buffer_load_dwordx4 v17, s[16:19], s62 offen   lds
    buffer_load_dwordx4 v18, s[16:19], s62 offen offset:1024  lds
    buffer_load_dwordx4 v19, s[16:19], s62 offen offset:2048  lds
    buffer_load_dwordx4 v20, s[16:19], s62 offen offset:3072  lds
    s_addk_i32 m0, 4096
    s_nop 0
    buffer_load_dwordx4 v21, s[16:19], s62 offen   lds
    buffer_load_dwordx4 v22, s[16:19], s62 offen offset:1024  lds
    buffer_load_dwordx4 v23, s[16:19], s62 offen offset:2048  lds
    s_addk_i32 s62, 128
    s_barrier
    s_mov_b32 m0, 73728
    s_nop 0
    buffer_load_dwordx4 v10, s[16:19], s62 offen   lds
    buffer_load_dwordx4 v11, s[16:19], s62 offen offset:1024  lds
    buffer_load_dwordx4 v12, s[16:19], s62 offen offset:2048  lds
    buffer_load_dwordx4 v13, s[16:19], s62 offen offset:3072  lds
    s_addk_i32 m0, 4096
    s_nop 0
    buffer_load_dwordx4 v14, s[16:19], s62 offen   lds
    buffer_load_dwordx4 v15, s[16:19], s62 offen offset:1024  lds
    buffer_load_dwordx4 v16, s[16:19], s62 offen offset:2048  lds
    s_waitcnt vmcnt(7)
    s_barrier
    s_mov_b32 m0, 80896
    s_nop 0
    buffer_load_dwordx4 v17, s[16:19], s62 offen   lds
    buffer_load_dwordx4 v18, s[16:19], s62 offen offset:1024  lds
    buffer_load_dwordx4 v19, s[16:19], s62 offen offset:2048  lds
    buffer_load_dwordx4 v20, s[16:19], s62 offen offset:3072  lds
    s_addk_i32 m0, 4096
    s_nop 0
    buffer_load_dwordx4 v21, s[16:19], s62 offen   lds
    buffer_load_dwordx4 v22, s[16:19], s62 offen offset:1024  lds
    buffer_load_dwordx4 v23, s[16:19], s62 offen offset:2048  lds
    s_addk_i32 s62, 128
    s_call_b64 s[70:71], S_voff0
    s_barrier
    s_mov_b32 m0, 88064
    s_nop 0
    buffer_load_dwordx4 v10, s[16:19], s62 offen   lds
    buffer_load_dwordx4 v11, s[16:19], s62 offen offset:1024  lds
    buffer_load_dwordx4 v12, s[16:19], s62 offen offset:2048  lds
    buffer_load_dwordx4 v13, s[16:19], s62 offen offset:3072  lds
    s_addk_i32 m0, 4096
    s_nop 0
    buffer_load_dwordx4 v14, s[16:19], s62 offen   lds
    buffer_load_dwordx4 v15, s[16:19], s62 offen offset:1024  lds
    buffer_load_dwordx4 v16, s[16:19], s62 offen offset:2048  lds
    s_waitcnt vmcnt(7)
    s_barrier
    s_mov_b32 m0, 95232
    s_nop 0
    buffer_load_dwordx4 v17, s[16:19], s62 offen   lds
    buffer_load_dwordx4 v18, s[16:19], s62 offen offset:1024  lds
    buffer_load_dwordx4 v19, s[16:19], s62 offen offset:2048  lds
    buffer_load_dwordx4 v20, s[16:19], s62 offen offset:3072  lds
    s_addk_i32 m0, 4096
    s_nop 0
    buffer_load_dwordx4 v21, s[16:19], s62 offen   lds
    buffer_load_dwordx4 v22, s[16:19], s62 offen offset:1024  lds
    buffer_load_dwordx4 v23, s[16:19], s62 offen offset:2048  lds
    s_addk_i32 s62, 128
    s_call_b64 s[70:71], S_voff1
    s_barrier
    s_mov_b32 m0, 102400
    s_nop 0
    buffer_load_dwordx4 v10, s[16:19], s62 offen   lds
    buffer_load_dwordx4 v11, s[16:19], s62 offen offset:1024  lds
    buffer_load_dwordx4 v12, s[16:19], s62 offen offset:2048  lds
    buffer_load_dwordx4 v13, s[16:19], s62 offen offset:3072  lds
    s_addk_i32 m0, 4096
    s_nop 0
    buffer_load_dwordx4 v14, s[16:19], s62 offen   lds
    buffer_load_dwordx4 v15, s[16:19], s62 offen offset:1024  lds
    buffer_load_dwordx4 v16, s[16:19], s62 offen offset:2048  lds
    s_waitcnt vmcnt(7)
    s_barrier
    s_mov_b32 m0, 109568
    s_nop 0
    buffer_load_dwordx4 v17, s[16:19], s62 offen   lds
    buffer_load_dwordx4 v18, s[16:19], s62 offen offset:1024  lds
    buffer_load_dwordx4 v19, s[16:19], s62 offen offset:2048  lds
    buffer_load_dwordx4 v20, s[16:19], s62 offen offset:3072  lds
    s_addk_i32 m0, 4096
    s_nop 0
    buffer_load_dwordx4 v21, s[16:19], s62 offen   lds
    buffer_load_dwordx4 v22, s[16:19], s62 offen offset:1024  lds
    buffer_load_dwordx4 v23, s[16:19], s62 offen offset:2048  lds
    s_addk_i32 s62, 128
    s_call_b64 s[70:71], S_voff2
    s_barrier
    s_mov_b32 m0, 73728
    s_nop 0
    buffer_load_dwordx4 v10, s[16:19], s62 offen   lds
    buffer_load_dwordx4 v11, s[16:19], s62 offen offset:1024  lds
    buffer_load_dwordx4 v12, s[16:19], s62 offen offset:2048  lds
    buffer_load_dwordx4 v13, s[16:19], s62 offen offset:3072  lds
    s_addk_i32 m0, 4096
    s_nop 0
    buffer_load_dwordx4 v14, s[16:19], s62 offen   lds
    buffer_load_dwordx4 v15, s[16:19], s62 offen offset:1024  lds
    buffer_load_dwordx4 v16, s[16:19], s62 offen offset:2048  lds
    s_waitcnt vmcnt(7)
    s_barrier
    s_mov_b32 m0, 80896
    s_nop 0
    buffer_load_dwordx4 v17, s[16:19], s62 offen   lds
    buffer_load_dwordx4 v18, s[16:19], s62 offen offset:1024  lds
    buffer_load_dwordx4 v19, s[16:19], s62 offen offset:2048  lds
    buffer_load_dwordx4 v20, s[16:19], s62 offen offset:3072  lds
    s_addk_i32 m0, 4096
    s_nop 0
    buffer_load_dwordx4 v21, s[16:19], s62 offen   lds
    buffer_load_dwordx4 v22, s[16:19], s62 offen offset:1024  lds
    buffer_load_dwordx4 v23, s[16:19], s62 offen offset:2048  lds
    s_addk_i32 s62, 128
    s_call_b64 s[70:71], S_voff3
    s_barrier
    s_mov_b32 m0, 88064
    s_nop 0
    buffer_load_dwordx4 v10, s[16:19], s62 offen   lds
    buffer_load_dwordx4 v11, s[16:19], s62 offen offset:1024  lds
    buffer_load_dwordx4 v12, s[16:19], s62 offen offset:2048  lds
    buffer_load_dwordx4 v13, s[16:19], s62 offen offset:3072  lds
    s_addk_i32 m0, 4096
    s_nop 0
    buffer_load_dwordx4 v14, s[16:19], s62 offen   lds
    buffer_load_dwordx4 v15, s[16:19], s62 offen offset:1024  lds
    buffer_load_dwordx4 v16, s[16:19], s62 offen offset:2048  lds
    s_waitcnt vmcnt(7)
    s_barrier
    s_mov_b32 m0, 95232
    s_nop 0
    buffer_load_dwordx4 v17, s[16:19], s62 offen   lds
    buffer_load_dwordx4 v18, s[16:19], s62 offen offset:1024  lds
    buffer_load_dwordx4 v19, s[16:19], s62 offen offset:2048  lds
    buffer_load_dwordx4 v20, s[16:19], s62 offen offset:3072  lds
    s_addk_i32 m0, 4096
    s_nop 0
    buffer_load_dwordx4 v21, s[16:19], s62 offen   lds
    buffer_load_dwordx4 v22, s[16:19], s62 offen offset:1024  lds
    buffer_load_dwordx4 v23, s[16:19], s62 offen offset:2048  lds
    s_addk_i32 s62, 128
    s_call_b64 s[70:71], S_voff4
    s_barrier
    s_mov_b32 m0, 102400
    s_nop 0
    buffer_load_dwordx4 v10, s[16:19], s62 offen   lds
    buffer_load_dwordx4 v11, s[16:19], s62 offen offset:1024  lds
    buffer_load_dwordx4 v12, s[16:19], s62 offen offset:2048  lds
    buffer_load_dwordx4 v13, s[16:19], s62 offen offset:3072  lds
    s_addk_i32 m0, 4096
    s_nop 0
    buffer_load_dwordx4 v14, s[16:19], s62 offen   lds
    buffer_load_dwordx4 v15, s[16:19], s62 offen offset:1024  lds
    buffer_load_dwordx4 v16, s[16:19], s62 offen offset:2048  lds
    s_waitcnt vmcnt(7)
    s_barrier
    s_mov_b64 s[36:37], s[48:49]
    s_mov_b32 s38, 256
    s_mov_b32 s39, 0x20000
    v_mov_b32 v4, 0
    buffer_load_dword v5, v4, s[36:39], 0 offen offset:128 sc1
    s_mov_b32 m0, 109568
    s_nop 0
    buffer_load_dwordx4 v17, s[16:19], s62 offen   lds
    buffer_load_dwordx4 v18, s[16:19], s62 offen offset:1024  lds
    buffer_load_dwordx4 v19, s[16:19], s62 offen offset:2048  lds
    buffer_load_dwordx4 v20, s[16:19], s62 offen offset:3072  lds
    s_addk_i32 m0, 4096
    s_nop 0
    buffer_load_dwordx4 v21, s[16:19], s62 offen   lds
    buffer_load_dwordx4 v22, s[16:19], s62 offen offset:1024  lds
    buffer_load_dwordx4 v23, s[16:19], s62 offen offset:2048  lds
    s_addk_i32 s62, 128
    s_call_b64 s[70:71], S_voff5
    s_barrier
    s_waitcnt vmcnt(0)
    v_cmp_ne_u32 vcc, 1, v5
    s_cbranch_vccz L_qx4
    s_mov_b64 s[36:37], s[48:49]
    s_mov_b32 s38, 256
    s_mov_b32 s39, 0x20000
    v_mov_b32 v4, 0
    s_mov_b64 exec, 1
    s_mov_b32 s74, 200000
L_hl3:
    buffer_load_dword v5, v4, s[36:39], 0 offen offset:128 sc1
    s_sub_u32 s74, s74, 1
    s_cbranch_scc1 L_hc4
    s_waitcnt vmcnt(0)
    v_cmp_ne_u32 vcc, 1, v5
    s_cbranch_vccz L_hc4
    s_branch L_hl3
L_hc4:
    s_mov_b64 exec, -1
L_qx4:
    s_barrier
    s_mov_b32 m0, 61440
    s_mov_b32 s66, 0
    s_call_b64 s[70:71], S_woround
    s_barrier
    s_mov_b32 m0, 81920
    s_mov_b32 s66, 20480
    s_call_b64 s[70:71], S_woround
    s_barrier
    s_mov_b32 m0, 0
    s_mov_b32 s66, 40960
    s_call_b64 s[70:71], S_woround
    s_mov_b32 m0, 20480
    s_mov_b32 s66, 61440
    s_call_b64 s[70:71], S_woround
    s_load_dwordx2 s[52:53], s[96:97], 8 glc
    s_mov_b32 m0, 40960
    s_mov_b32 s66, 81920
    s_call_b64 s[70:71], S_woround
    s_waitcnt lgkmcnt(0)
    s_cmp_eq_u32 s52, 1
    s_cbranch_scc1 L_qx3
    s_mov_b32 s74, 200000
L_sp5:
    s_load_dwordx2 s[52:53], s[96:97], 8 glc
    s_sub_u32 s74, s74, 1
    s_cbranch_scc1 L_spe6
    s_waitcnt lgkmcnt(0)
    s_cmp_eq_u32 s52, 1
    s_cbranch_scc0 L_sp5
L_spe6:
L_qx3:
    s_add_u32 s16, s50, 2621440
    s_addc_u32 s17, s51, 0
    s_mov_b32 s18, 2891776
    s_mov_b32 s19, 0x20000
    s_mul_i32 s64, s28, 90112
    s_and_b32 s65, s24, 3
    s_lshl_b32 s63, s65, 6
    s_add_u32 s63, s63, 105472
    s_lshl_b32 s65, s65, 10
    s_add_u32 s65, s65, 143360
    s_mov_b64 s[12:13], s[50:51]
    s_mov_b32 s14, 2621440
    s_mov_b32 s15, 0x20000
    s_mov_b32 m0, s99
    s_mul_i32 s62, s98, 1280
    s_barrier
    s_mov_b32 s54, 1
    s_atomic_add s54, s[32:33], s101 glc
    s_barrier
    s_waitcnt lgkmcnt(0)
    s_cmp_lg_u32 s54, 39
    s_cbranch_scc1 L_arr7
    buffer_store_dword v27, v26, s[32:35], s100 offen sc1
L_arr7:
    s_barrier
    s_waitcnt vmcnt(1)
    s_cmp_eq_u32 s54, 39
    s_cbranch_scc1 L_qx5
    s_waitcnt vmcnt(0)
L_qx5:
L_ldpoll:
    s_mov_b32 s74, 200000
L_sp8:
    s_load_dwordx2 s[52:53], s[96:97], 0 glc
    s_sub_u32 s74, s74, 1
    s_cbranch_scc1 L_spe9
    s_waitcnt lgkmcnt(0)
    s_add_u32 s52, s52, s53
    s_cmp_eq_u32 s52, 2
    s_cbranch_scc0 L_sp8
L_spe9:
    s_branch L_ldG
S_ldsetup:
    s_and_b32 s27, s26, 7
    s_lshr_b32 s72, s26, 3
    s_and_b32 s28, s25, 3
    s_lshl2_add_u32 s28, s28, s72
    s_lshr_b32 s73, s25, 2
    s_lshl1_add_u32 s28, s28, s73
    s_sub_u32 s29, 64, s28
    s_cmp_eq_u32 s28, 0
    s_cselect_b32 s29, 32, s29
    s_and_b32 s73, s24, 3
    s_cmp_lt_u32 s73, 2
    s_cselect_b32 s98, s28, s29
    s_and_b32 s72, s73, 1
    s_lshl_b32 s72, s72, 10
    s_add_u32 s98, s98, s72
    s_mul_i32 s99, s73, 10240
    s_add_u32 s99, s99, 102400
    s_add_u32 s32, s50, 5570560
    s_addc_u32 s33, s51, 0
    s_mov_b32 s34, 40960
    s_mov_b32 s35, 0x20000
    v_lshlrev_b32 v32, 4, v0
    s_mul_i32 s67, s73, 5120
    s_mul_i32 s72, s27, 102400
    s_add_u32 s72, s72, 6422528
    s_add_u32 s40, s50, s72
    s_addc_u32 s41, s51, 0
    s_mov_b32 s42, 102400
    s_mov_b32 s43, 0x20000
    v_lshrrev_b32 v33, 3, v0
    v_mul_u32_u24 v33, 81920, v33
    v_and_b32 v34, 7, v0
    v_lshrrev_b32 v35, 4, v0
    v_xor_b32 v34, v34, v35
    v_lshl_add_u32 v33, v34, 4, v33
    v_xor_b32 v34, 64, v33
    v_add_u32 v34, 654336, v34
    s_lshr_b32 s72, s2, 4
    s_and_b32 s73, s2, 3
    s_lshl2_add_u32 s72, s72, s73
    s_lshl_b32 s72, s72, 7
    s_bfe_u32 s73, s2, 0x10002
    s_lshl_b32 s73, s73, 13
    s_add_u32 s73, s73, s72
    s_addk_i32 s73, 8192
    s_add_u32 s96, s32, s73
    s_addc_u32 s97, s33, 0
    s_and_b32 s73, s24, 3
    s_lshl2_add_u32 s73, s26, s73
    s_lshl_b32 s73, s73, 7
    s_addk_i32 s73, 24576
    s_add_u32 s30, s32, s73
    s_addc_u32 s31, s33, 0
    s_setpc_b64 s[70:71]
S_woround:
    s_add_u32 m0, m0, s67
    s_add_u32 s66, s66, s67
    s_add_u32 s72, s66, 4096
    buffer_load_dwordx4 v32, s[40:43], s66 offen  sc1 lds
    buffer_load_dwordx4 v32, s[40:43], s66 offen offset:1024 sc1 lds
    buffer_load_dwordx4 v32, s[40:43], s66 offen offset:2048 sc1 lds
    buffer_load_dwordx4 v32, s[40:43], s66 offen offset:3072 sc1 lds
    s_addk_i32 m0, 4096
    s_nop 0
    buffer_load_dwordx4 v32, s[40:43], s72 offen  sc1 lds
    s_setpc_b64 s[70:71]
S_cinit:
    s_and_b32 s27, s26, 7
    s_lshr_b32 s72, s26, 3
    s_and_b32 s28, s25, 3
    s_lshl2_add_u32 s28, s28, s72
    s_lshr_b32 s73, s25, 2
    s_lshl1_add_u32 s28, s28, s73
    s_sub_u32 s29, 64, s28
    s_cmp_eq_u32 s28, 0
    s_cselect_b32 s29, 32, s29
    s_and_b32 s73, s24, 3
    s_cmp_lt_u32 s73, 2
    s_cselect_b32 s98, s28, s29
    s_and_b32 s72, s73, 1
    s_lshl_b32 s72, s72, 10
    s_add_u32 s98, s98, s72
    s_mul_i32 s99, s73, 10240
    s_add_u32 s99, s99, 102400
    s_lshl_b32 s42, s24, 6
    s_add_u32 s42, s42, 105472
    s_mul_i32 s41, s98, 1280
    s_mul_i32 s72, s27, 160
    s_add_u32 s41, s41, s72
    s_cmp_lt_u32 s27, 4
    s_cselect_b32 s67, -1.0, 1.0
    s_cmp_lt_u32 s24, 2
    s_cselect_b32 s65, -1.0, 1.0
    s_cselect_b32 s72, 0, 0x80000000
    s_cselect_b32 s73, 0, 1
    s_xor_b32 s68, s67, s72
    s_cmp_eq_u32 s28, 0
    s_cselect_b32 s65, 0, s65
    s_cselect_b32 s68, 0, s68
    s_cselect_b32 s73, s73, 0
    s_cmp_eq_u32 s73, 1
    s_cselect_b32 s64, 0, 1.0
    s_cselect_b32 s66, 1.0, 0
    s_cselect_b32 s69, s67, 0
    s_cselect_b32 s67, 0, s67
    s_mov_b64 s[36:37], s[46:47]
    s_mov_b32 s38, 2621440
    s_mov_b32 s39, 0x20000
    s_setpc_b64 s[70:71]
S_voff:
S_voff0:
    v_mbcnt_lo_u32_b32 v76, -1, 0
    v_mbcnt_hi_u32_b32 v76, -1, v76
    s_sub_u32 s76, 7, s27
    s_min_u32 s75, s76, s27
    s_mulk_i32 s75, 88
    s_bitcmp1_b32 s27, 0
    s_cselect_b32 s76, 80, 0
    s_add_u32 s75, s75, s76
    s_bitcmp1_b32 s27, 0
    s_cselect_b32 s76, -1, 1
    s_and_b32 s74, s24, 3
    s_lshl_b32 s74, s74, 6
    v_add_u32 v75, s74, v76
    v_add_u32 v77, 0, v75
    v_mul_u32_u24 v78, 3277, v77
    v_lshrrev_b32 v78, 18, v78
    v_mul_u32_u24 v79, 80, v78
    v_sub_u32 v79, v77, v79
    v_mul_i32_i24 v79, s76, v79
    v_add_u32 v79, s75, v79
    v_mul_u32_u24 v78, 5632, v78
    v_lshl_add_u32 v70, v79, 4, v78
    s_setpc_b64 s[70:71]
S_voff1:
    v_add_u32 v77, 256, v75
    v_mul_u32_u24 v78, 3277, v77
    v_lshrrev_b32 v78, 18, v78
    v_mul_u32_u24 v79, 80, v78
    v_sub_u32 v79, v77, v79
    v_mul_i32_i24 v79, s76, v79
    v_add_u32 v79, s75, v79
    v_mul_u32_u24 v78, 5632, v78
    v_lshl_add_u32 v71, v79, 4, v78
    s_setpc_b64 s[70:71]
S_voff2:
    v_add_u32 v77, 512, v75
    v_mul_u32_u24 v78, 3277, v77
    v_lshrrev_b32 v78, 18, v78
    v_mul_u32_u24 v79, 80, v78
    v_sub_u32 v79, v77, v79
    v_mul_i32_i24 v79, s76, v79
    v_add_u32 v79, s75, v79
    v_mul_u32_u24 v78, 5632, v78
    v_lshl_add_u32 v72, v79, 4, v78
    s_setpc_b64 s[70:71]
S_voff3:
    v_add_u32 v77, 768, v75
    v_mul_u32_u24 v78, 3277, v77
    v_lshrrev_b32 v78, 18, v78
    v_mul_u32_u24 v79, 80, v78
    v_sub_u32 v79, v77, v79
    v_mul_i32_i24 v79, s76, v79
    v_add_u32 v79, s75, v79
    v_mul_u32_u24 v78, 5632, v78
    v_lshl_add_u32 v73, v79, 4, v78
    s_setpc_b64 s[70:71]
S_voff4:
    v_add_u32 v77, 1024, v75
    v_mul_u32_u24 v78, 3277, v77
    v_lshrrev_b32 v78, 18, v78
    v_mul_u32_u24 v79, 80, v78
    v_sub_u32 v79, v77, v79
    v_mul_i32_i24 v79, s76, v79
    v_add_u32 v79, s75, v79
    v_mul_u32_u24 v78, 5632, v78
    v_lshl_add_u32 v74, v79, 4, v78
    s_setpc_b64 s[70:71]
S_voff5:
    v_lshlrev_b32 v77, 6, v76
    v_add_u32 v77, s98, v77
    v_lshrrev_b32 v78, 5, v77
    v_and_b32 v77, 31, v77
    v_and_b32 v79, 32, v78
    v_lshl_add_u32 v77, v77, 6, v79
    v_and_b32 v79, 4, v78
    v_lshl_add_u32 v77, v79, 2, v77
    v_and_b32 v79, 1, v78
    v_lshl_add_u32 v77, v79, 3, v77
    v_bfe_u32 v79, v78, 3, 2
    v_lshl_add_u32 v77, v79, 1, v77
    v_bfe_u32 v79, v78, 1, 1
    v_add_lshl_u32 v75, v77, v79, 2
    v_add_u32 v75, 2883584, v75
    s_setpc_b64 s[70:71]
L_fl:
    s_cmp_lg_u32 s24, 7
    s_cbranch_scc1 L_l110
    s_mul_i32 s63, s25, 10
    s_add_u32 s63, s63, s52
    s_mulk_i32 s63, 6144
    s_add_u32 s63, s63, 983040
    v_lshlrev_b32 v19, 7, v0
    s_mov_b32 exec_hi, 0xffff
    buffer_load_dword v15, v19, s[16:19], s63 offen
    s_add_u32 s63, s63, 491520
    buffer_load_dword v15, v19, s[16:19], s63 offen
    s_add_u32 s63, s63, 491520
    buffer_load_dword v15, v19, s[16:19], s63 offen
    s_add_u32 s63, s63, 491520
    s_mov_b32 exec_hi, -1
L_l110:
    s_sub_u32 s52, s26, 20
    s_cmp_ge_u32 s52, 3
    s_cselect_b32 s53, 1, 0
    s_mul_i32 s54, s53, 3
    s_sub_u32 s54, s52, s54
    s_lshl1_add_u32 s55, s25, s53
    s_lshl1_add_u32 s59, s54, s25
    s_cmp_ge_u32 s59, 10
    s_cselect_b32 s61, 10, 0
    s_sub_u32 s59, s59, s61
    v_and_b32 v3, 7, v0
    v_bfe_u32 v4, v0, 4, 1
    v_lshlrev_b32 v4, 2, v4
    v_xor_b32 v3, v3, v4
    v_lshlrev_b32 v3, 4, v3
    v_bfe_u32 v2, v0, 3, 2
    v_lshrrev_b32 v4, 5, v0
    v_lshl_add_u32 v2, v2, 3, v4
    v_mul_u32_u24 v2, 40960, v2
    v_add_u32 v10, v3, v2
    v_add_u32 v11, 80896, v10
    v_add_u32 v12, 80896, v11
    v_add_u32 v13, 80896, v12
    s_and_b32 s61, s60, 1
    s_mul_i32 s61, s61, 1310720
    s_lshr_b32 s62, s60, 1
    s_lshl1_add_u32 s56, s55, s62
    s_mul_i32 s62, s56, 1280
    s_add_u32 s57, s61, s62
    s_lshl_b32 s62, s59, 7
    s_mul_i32 s65, s60, 24576
    s_add_u32 s65, s65, 65536
    s_mov_b64 s[12:13], s[4:5]
    s_mov_b32 s14, 2621440
    s_mov_b32 s15, 0x20000
    s_mov_b64 s[20:21], s[44:45]
    s_mov_b32 s22, 1280
    s_mov_b32 s23, 0x20000
    s_mul_i32 s63, s60, 640
    s_add_u32 m0, s63, 61440
    s_and_b32 s63, s60, 1
    s_mulk_i32 s63, 640
    v_lshlrev_b32 v17, 4, v0
    s_mov_b32 exec_hi, 0xff
    buffer_load_dwordx4 v17, s[20:23], s63 offen lds
    s_mov_b32 exec_hi, -1
    s_add_u32 s63, s62, 61440
    v_add_u32 v16, s63, v3
    s_and_b32 s61, s54, 1
    s_lshl_b32 s61, s61, 11
    s_add_u32 s61, s61, s65
    v_add_u32 v18, s61, v17
    s_add_u32 m0, s65, 0
    s_add_u32 s63, s62, s57
    buffer_load_dwordx4 v10, s[12:15], s63 offen   lds
    buffer_load_dwordx4 v11, s[12:15], s63 offen offset:1024  lds
    buffer_load_dwordx4 v12, s[12:15], s63 offen offset:2048  lds
    buffer_load_dwordx4 v13, s[12:15], s63 offen offset:3072  lds
    s_addk_i32 s62, 640
    s_cmpk_ge_u32 s62, 1280
    s_cselect_b32 s63, 1280, 0
    s_sub_u32 s62, s62, s63
    s_add_u32 m0, s65, 4096
    s_add_u32 s63, s62, s57
    buffer_load_dwordx4 v10, s[12:15], s63 offen   lds
    buffer_load_dwordx4 v11, s[12:15], s63 offen offset:1024  lds
    buffer_load_dwordx4 v12, s[12:15], s63 offen offset:2048  lds
    buffer_load_dwordx4 v13, s[12:15], s63 offen offset:3072  lds
    s_addk_i32 s62, 768
    s_cmpk_ge_u32 s62, 1280
    s_cselect_b32 s63, 1280, 0
    s_sub_u32 s62, s62, s63
    s_call_b64 s[70:71], S_ldsetup
    v_lshlrev_b32 v26, 7, v0
    v_mov_b32 v27, 1
    v_mov_b32 v28, 1
    s_movk_i32 s100, 24576
    s_mov_b64 s[36:37], s[48:49]
    s_mov_b32 s38, 256
    s_mov_b32 s39, 0x20000
    s_call_b64 s[70:71], S_voff0
    s_call_b64 s[70:71], S_voff1
    s_call_b64 s[70:71], S_voff2
    s_call_b64 s[70:71], S_voff3
    s_call_b64 s[70:71], S_voff4
    s_call_b64 s[70:71], S_voff5
    s_add_u32 m0, s65, 8192
    s_add_u32 s63, s62, s57
    buffer_load_dwordx4 v10, s[12:15], s63 offen   lds
    buffer_load_dwordx4 v11, s[12:15], s63 offen offset:1024  lds
    buffer_load_dwordx4 v12, s[12:15], s63 offen offset:2048  lds
    buffer_load_dwordx4 v13, s[12:15], s63 offen offset:3072  lds
    s_addk_i32 s62, 640
    s_cmpk_ge_u32 s62, 1280
    s_cselect_b32 s63, 1280, 0
    s_sub_u32 s62, s62, s63
    s_add_u32 m0, s65, 12288
    s_add_u32 s63, s62, s57
    buffer_load_dwordx4 v10, s[12:15], s63 offen   lds
    buffer_load_dwordx4 v11, s[12:15], s63 offen offset:1024  lds
    buffer_load_dwordx4 v12, s[12:15], s63 offen offset:2048  lds
    buffer_load_dwordx4 v13, s[12:15], s63 offen offset:3072  lds
    s_addk_i32 s62, 768
    s_cmpk_ge_u32 s62, 1280
    s_cselect_b32 s63, 1280, 0
    s_sub_u32 s62, s62, s63
    s_waitcnt vmcnt(8)
    s_barrier
    ds_read_b128 v[80:83], v16 offset:0
    ds_read_b128 v[88:91], v18 offset:0
    ds_read_b128 v[92:95], v18 offset:1024
    ds_read_b128 v[84:87], v16 offset:640
    ds_read_b128 v[96:99], v18 offset:4096
    ds_read_b128 v[100:103], v18 offset:5120
    s_add_u32 m0, s65, 16384
    s_add_u32 s63, s62, s57
    buffer_load_dwordx4 v10, s[12:15], s63 offen   lds
    buffer_load_dwordx4 v11, s[12:15], s63 offen offset:1024  lds
    buffer_load_dwordx4 v12, s[12:15], s63 offen offset:2048  lds
    buffer_load_dwordx4 v13, s[12:15], s63 offen offset:3072  lds
    s_addk_i32 s62, 640
    s_cmpk_ge_u32 s62, 1280
    s_cselect_b32 s63, 1280, 0
    s_sub_u32 s62, s62, s63
    s_add_u32 m0, s65, 20480
    s_add_u32 s63, s62, s57
    buffer_load_dwordx4 v10, s[12:15], s63 offen   lds
    buffer_load_dwordx4 v11, s[12:15], s63 offen offset:1024  lds
    buffer_load_dwordx4 v12, s[12:15], s63 offen offset:2048  lds
    buffer_load_dwordx4 v13, s[12:15], s63 offen offset:3072  lds
    s_addk_i32 s62, 768
    s_cmpk_ge_u32 s62, 1280
    s_cselect_b32 s63, 1280, 0
    s_sub_u32 s62, s62, s63
    s_waitcnt lgkmcnt(0)
    v_dot2_f32_bf16 v104, v88, v80, 0
    v_dot2_f32_bf16 v105, v92, v80, 0
    v_dot2_f32_bf16 v104, v89, v81, v104
    v_dot2_f32_bf16 v105, v93, v81, v105
    v_dot2_f32_bf16 v104, v90, v82, v104
    v_dot2_f32_bf16 v105, v94, v82, v105
    v_dot2_f32_bf16 v104, v91, v83, v104
    v_dot2_f32_bf16 v105, v95, v83, v105
    v_dot2_f32_bf16 v104, v96, v84, v104
    v_dot2_f32_bf16 v105, v100, v84, v105
    v_dot2_f32_bf16 v104, v97, v85, v104
    v_dot2_f32_bf16 v105, v101, v85, v105
    v_dot2_f32_bf16 v104, v98, v86, v104
    v_dot2_f32_bf16 v105, v102, v86, v105
    v_dot2_f32_bf16 v104, v99, v87, v104
    v_dot2_f32_bf16 v105, v103, v87, v105
    s_waitcnt vmcnt(8)
    s_barrier
    ds_read_b128 v[80:83], v16 offset:128
    ds_read_b128 v[88:91], v18 offset:8192
    ds_read_b128 v[92:95], v18 offset:9216
    ds_read_b128 v[84:87], v16 offset:768
    ds_read_b128 v[96:99], v18 offset:12288
    ds_read_b128 v[100:103], v18 offset:13312
    s_add_u32 m0, s65, 0
    s_add_u32 s63, s62, s57
    buffer_load_dwordx4 v10, s[12:15], s63 offen   lds
    buffer_load_dwordx4 v11, s[12:15], s63 offen offset:1024  lds
    buffer_load_dwordx4 v12, s[12:15], s63 offen offset:2048  lds
    buffer_load_dwordx4 v13, s[12:15], s63 offen offset:3072  lds
    s_addk_i32 s62, 640
    s_cmpk_ge_u32 s62, 1280
    s_cselect_b32 s63, 1280, 0
    s_sub_u32 s62, s62, s63
    s_add_u32 m0, s65, 4096
    s_add_u32 s63, s62, s57
    buffer_load_dwordx4 v10, s[12:15], s63 offen   lds
    buffer_load_dwordx4 v11, s[12:15], s63 offen offset:1024  lds
    buffer_load_dwordx4 v12, s[12:15], s63 offen offset:2048  lds
    buffer_load_dwordx4 v13, s[12:15], s63 offen offset:3072  lds
    s_addk_i32 s62, 768
    s_cmpk_ge_u32 s62, 1280
    s_cselect_b32 s63, 1280, 0
    s_sub_u32 s62, s62, s63
    s_waitcnt lgkmcnt(0)
    v_dot2_f32_bf16 v104, v88, v80, v104
    v_dot2_f32_bf16 v105, v92, v80, v105
    v_dot2_f32_bf16 v104, v89, v81, v104
    v_dot2_f32_bf16 v105, v93, v81, v105
    v_dot2_f32_bf16 v104, v90, v82, v104
    v_dot2_f32_bf16 v105, v94, v82, v105
    v_dot2_f32_bf16 v104, v91, v83, v104
    v_dot2_f32_bf16 v105, v95, v83, v105
    v_dot2_f32_bf16 v104, v96, v84, v104
    v_dot2_f32_bf16 v105, v100, v84, v105
    v_dot2_f32_bf16 v104, v97, v85, v104
    v_dot2_f32_bf16 v105, v101, v85, v105
    v_dot2_f32_bf16 v104, v98, v86, v104
    v_dot2_f32_bf16 v105, v102, v86, v105
    v_dot2_f32_bf16 v104, v99, v87, v104
    v_dot2_f32_bf16 v105, v103, v87, v105
    s_waitcnt vmcnt(8)
    s_barrier
    ds_read_b128 v[80:83], v16 offset:256
    ds_read_b128 v[88:91], v18 offset:16384
    ds_read_b128 v[92:95], v18 offset:17408
    ds_read_b128 v[84:87], v16 offset:896
    ds_read_b128 v[96:99], v18 offset:20480
    ds_read_b128 v[100:103], v18 offset:21504
    s_add_u32 m0, s65, 8192
    s_add_u32 s63, s62, s57
    buffer_load_dwordx4 v10, s[12:15], s63 offen   lds
    buffer_load_dwordx4 v11, s[12:15], s63 offen offset:1024  lds
    buffer_load_dwordx4 v12, s[12:15], s63 offen offset:2048  lds
    buffer_load_dwordx4 v13, s[12:15], s63 offen offset:3072  lds
    s_addk_i32 s62, 640
    s_cmpk_ge_u32 s62, 1280
    s_cselect_b32 s63, 1280, 0
    s_sub_u32 s62, s62, s63
    s_add_u32 m0, s65, 12288
    s_add_u32 s63, s62, s57
    buffer_load_dwordx4 v10, s[12:15], s63 offen   lds
    buffer_load_dwordx4 v11, s[12:15], s63 offen offset:1024  lds
    buffer_load_dwordx4 v12, s[12:15], s63 offen offset:2048  lds
    buffer_load_dwordx4 v13, s[12:15], s63 offen offset:3072  lds
    s_addk_i32 s62, 768
    s_cmpk_ge_u32 s62, 1280
    s_cselect_b32 s63, 1280, 0
    s_sub_u32 s62, s62, s63
    s_waitcnt lgkmcnt(0)
    v_dot2_f32_bf16 v104, v88, v80, v104
    v_dot2_f32_bf16 v105, v92, v80, v105
    v_dot2_f32_bf16 v104, v89, v81, v104
    v_dot2_f32_bf16 v105, v93, v81, v105
    v_dot2_f32_bf16 v104, v90, v82, v104
    v_dot2_f32_bf16 v105, v94, v82, v105
    v_dot2_f32_bf16 v104, v91, v83, v104
    v_dot2_f32_bf16 v105, v95, v83, v105
    v_dot2_f32_bf16 v104, v96, v84, v104
    v_dot2_f32_bf16 v105, v100, v84, v105
    v_dot2_f32_bf16 v104, v97, v85, v104
    v_dot2_f32_bf16 v105, v101, v85, v105
    v_dot2_f32_bf16 v104, v98, v86, v104
    v_dot2_f32_bf16 v105, v102, v86, v105
    v_dot2_f32_bf16 v104, v99, v87, v104
    v_dot2_f32_bf16 v105, v103, v87, v105
    s_waitcnt vmcnt(8)
    s_barrier
    ds_read_b128 v[80:83], v16 offset:384
    ds_read_b128 v[88:91], v18 offset:0
    ds_read_b128 v[92:95], v18 offset:1024
    ds_read_b128 v[84:87], v16 offset:1024
    ds_read_b128 v[96:99], v18 offset:4096
    ds_read_b128 v[100:103], v18 offset:5120
    s_waitcnt lgkmcnt(0)
    v_dot2_f32_bf16 v104, v88, v80, v104
    v_dot2_f32_bf16 v105, v92, v80, v105
    v_dot2_f32_bf16 v104, v89, v81, v104
    v_dot2_f32_bf16 v105, v93, v81, v105
    v_dot2_f32_bf16 v104, v90, v82, v104
    v_dot2_f32_bf16 v105, v94, v82, v105
    v_dot2_f32_bf16 v104, v91, v83, v104
    v_dot2_f32_bf16 v105, v95, v83, v105
    v_dot2_f32_bf16 v104, v96, v84, v104
    v_dot2_f32_bf16 v105, v100, v84, v105
    v_dot2_f32_bf16 v104, v97, v85, v104
    v_dot2_f32_bf16 v105, v101, v85, v105
    v_dot2_f32_bf16 v104, v98, v86, v104
    v_dot2_f32_bf16 v105, v102, v86, v105
    v_dot2_f32_bf16 v104, v99, v87, v104
    v_dot2_f32_bf16 v105, v103, v87, v105
    s_waitcnt vmcnt(0)
    s_barrier
    ds_read_b128 v[80:83], v16 offset:512
    ds_read_b128 v[88:91], v18 offset:8192
    ds_read_b128 v[92:95], v18 offset:9216
    ds_read_b128 v[84:87], v16 offset:1152
    ds_read_b128 v[96:99], v18 offset:12288
    ds_read_b128 v[100:103], v18 offset:13312
    v_mov_b32 v4, 0
    buffer_load_dword v5, v4, s[36:39], 0 offen offset:128 sc1
    s_waitcnt vmcnt(0)
    v_cmp_ne_u32 vcc, 1, v5
    s_cbranch_vccz L_f1
    s_cmp_lg_u32 s24, 7
    s_cbranch_scc1 L_f1
    s_mov_b64 s[36:37], s[48:49]
    s_mov_b32 s38, 256
    s_mov_b32 s39, 0x20000
    v_mov_b32 v4, 0
    s_mov_b64 exec, 1
    s_mov_b32 s74, 200000
L_hl11:
    buffer_load_dword v5, v4, s[36:39], 0 offen offset:128 sc1
    s_sub_u32 s74, s74, 1
    s_cbranch_scc1 L_hc12
    s_waitcnt vmcnt(0)
    v_cmp_ne_u32 vcc, 1, v5
    s_cbranch_vccz L_hc12
    s_branch L_hl11
L_hc12:
    s_mov_b64 exec, -1
L_f1:
    s_waitcnt lgkmcnt(0)
    v_dot2_f32_bf16 v104, v88, v80, v104
    v_dot2_f32_bf16 v105, v92, v80, v105
    v_dot2_f32_bf16 v104, v89, v81, v104
    v_dot2_f32_bf16 v105, v93, v81, v105
    v_dot2_f32_bf16 v104, v90, v82, v104
    v_dot2_f32_bf16 v105, v94, v82, v105
    v_dot2_f32_bf16 v104, v91, v83, v104
    v_dot2_f32_bf16 v105, v95, v83, v105
    v_dot2_f32_bf16 v104, v96, v84, v104
    v_dot2_f32_bf16 v105, v100, v84, v105
    v_dot2_f32_bf16 v104, v97, v85, v104
    v_dot2_f32_bf16 v105, v101, v85, v105
    v_dot2_f32_bf16 v104, v98, v86, v104
    v_dot2_f32_bf16 v105, v102, v86, v105
    v_dot2_f32_bf16 v104, v99, v87, v104
    v_dot2_f32_bf16 v105, v103, v87, v105
    s_barrier
    s_nop 0
    v_add_f32_dpp v104, v104, v104 quad_perm:[1,0,3,2] row_mask:0xf bank_mask:0xf
    v_add_f32_dpp v105, v105, v105 quad_perm:[1,0,3,2] row_mask:0xf bank_mask:0xf
    s_nop 0
    v_add_f32_dpp v104, v104, v104 quad_perm:[2,3,0,1] row_mask:0xf bank_mask:0xf
    v_add_f32_dpp v105, v105, v105 quad_perm:[2,3,0,1] row_mask:0xf bank_mask:0xf
    s_nop 0
    v_add_f32_dpp v104, v104, v104 row_half_mirror row_mask:0xf bank_mask:0xf
    v_add_f32_dpp v105, v105, v105 row_half_mirror row_mask:0xf bank_mask:0xf
    v_and_b32 v19, 1, v0
    v_cmp_eq_u32 vcc, 1, v19
    s_and_b32 s61, s60, 1
    s_lshl1_add_u32 s58, s56, s61
    s_lshl1_add_u32 s58, s58, s54
    s_lshl_b32 s58, s58, 6
    s_cmp_eq_u32 s54, 2
    s_cselect_b32 s58, 8192, s58
    v_cndmask_b32 v104, v104, v105, vcc
    v_mul_f32 v104, 0xbfb8aa3b, v104
    v_exp_f32 v104, v104
    v_and_b32 v17, 0x39, v0
    v_cmp_eq_u32 vcc, v17, v0
    v_add_f32 v104, 1.0, v104
    v_rcp_f32 v104, v104
    v_mul_u32_u24 v19, 3, v19
    v_add_u32 v17, v17, v19
    v_bfrev_b32 v19, 1
    v_cndmask_b32 v17, v19, v17, vcc
    s_add_u32 s20, s50, 5505024
    s_addc_u32 s21, s51, 0
    s_mov_b32 s22, 8192
    s_mov_b32 s23, 0x20000
    buffer_store_dword v104, v17, s[20:23], s58 offen sc1
    s_mov_b32 m0, 0
    s_mov_b32 s66, 40960
    s_call_b64 s[70:71], S_woround
    s_mov_b32 m0, 20480
    s_mov_b32 s66, 61440
    s_call_b64 s[70:71], S_woround
    s_barrier
    s_barrier
    s_waitcnt vmcnt(0)
    s_barrier
    s_mov_b32 m0, 61440
    s_mov_b32 s66, 0
    s_call_b64 s[70:71], S_woround
    s_mov_b32 m0, 81920
    s_mov_b32 s66, 20480
    s_call_b64 s[70:71], S_woround
    s_barrier
    s_mov_b32 s54, 1
    s_cmp_lg_u32 s24, 7
    s_cbranch_scc1 L_nqwo
    s_atomic_add s54, s[32:33], 1024 glc
L_nqwo:
    s_mov_b32 m0, 40960
    s_mov_b32 s66, 81920
    s_call_b64 s[70:71], S_woround
    s_add_u32 s16, s50, 2621440
    s_addc_u32 s17, s51, 0
    s_mov_b32 s18, 2891776
    s_mov_b32 s19, 0x20000
    s_mul_i32 s64, s28, 90112
    s_and_b32 s65, s24, 3
    s_lshl_b32 s63, s65, 6
    s_add_u32 s63, s63, 105472
    s_lshl_b32 s65, s65, 10
    s_add_u32 s65, s65, 143360
    s_mov_b64 s[12:13], s[50:51]
    s_mov_b32 s14, 2621440
    s_mov_b32 s15, 0x20000
    s_mov_b32 m0, s99
    s_mul_i32 s62, s98, 1280
    s_waitcnt lgkmcnt(0)
    s_cmp_lg_u32 s54, 47
    s_cbranch_scc1 L_fr13
    buffer_store_dword v27, v26, s[32:35], s100 offen sc1
    s_addk_i32 s100, 8192
    buffer_store_dword v27, v26, s[32:35], s100 offen sc1
    s_waitcnt vmcnt(2)
    s_branch L_ldpoll
L_fr13:
    s_waitcnt vmcnt(0)
    s_branch L_nqw3
L_nqw2:
    s_add_u32 s16, s50, 2621440
    s_addc_u32 s17, s51, 0
    s_mov_b32 s18, 2891776
    s_mov_b32 s19, 0x20000
    s_mul_i32 s64, s28, 90112
    s_and_b32 s65, s24, 3
    s_lshl_b32 s63, s65, 6
    s_add_u32 s63, s63, 105472
    s_lshl_b32 s65, s65, 10
    s_add_u32 s65, s65, 143360
    s_mov_b64 s[12:13], s[50:51]
    s_mov_b32 s14, 2621440
    s_mov_b32 s15, 0x20000
    s_mov_b32 m0, s99
    s_mul_i32 s62, s98, 1280
L_nqw3:
    s_cmp_eq_u32 s24, 7
    s_cbranch_scc1 L_ldpoll
    s_branch L_ldG
L_fc:
    s_sub_u32 s52, s26, 20
    s_cmp_ge_u32 s52, 3
    s_cselect_b32 s53, 1, 0
    s_mul_i32 s54, s53, 3
    s_sub_u32 s54, s52, s54
    s_lshl1_add_u32 s55, s25, s53
    s_lshl1_add_u32 s59, s54, s25
    s_cmp_ge_u32 s59, 10
    s_cselect_b32 s61, 10, 0
    s_sub_u32 s59, s59, s61
    v_and_b32 v1, 15, v0
    v_lshrrev_b32 v2, 4, v0
    v_mul_u32_u24 v4, 180224, v2
    v_lshl_add_u32 v252, v1, 4, v4
    s_cmp_eq_u32 s54, 2
    s_cselect_b32 s60, 4, 16
    v_cmp_gt_u32 vcc, s60, v1
    v_bfrev_b32 v4, 1
    s_mul_i32 s62, s55, 5632
    s_mul_i32 s61, s24, 1408
    v_cndmask_b32 v253, v4, v252, vcc
    s_add_u32 s62, s62, s61
    s_lshl_b32 s61, s54, 9
    s_add_u32 s62, s62, s61
    v_and_b32 v3, 3, v0
    v_lshrrev_b32 v4, 2, v0
    v_lshlrev_b32 v4, 3, v4
    v_and_b32 v5, 2, v0
    v_lshlrev_b32 v5, 5, v5
    v_xor_b32 v4, v4, v5
    v_lshl_add_u32 v4, v3, 7, v4
    s_mul_i32 s61, s24, 24576
    s_add_u32 s61, s61, 65536
    v_add_u32 v251, s61, v4
    s_lshl_b32 s61, s24, 10
    s_add_u32 s61, s61, 98304
    v_lshl_add_u32 v254, v0, 4, s61
    v_and_b32 v4, 1, v1
    v_mul_u32_u24 v4, 0x8000, v4
    v_lshl_add_u32 v250, v4, 16, v4
    s_lshl_b32 s61, s59, 2
    v_add_u32 v8, s61, v2
    s_lshl_b32 s60, s54, 5
    v_add_u32 v3, s60, v1
    s_add_u32 s60, s60, 16
    v_cmp_ge_u32 vcc, 80, v3
    s_nop 1
    v_cndmask_b32 v3, 0, v3, vcc
    v_cvt_f32_u32 v6, v3
    v_mul_f32 v248, 0x3bcccccd, v6
    v_mul_u32_u24 v4, v8, v3
    v_mul_u32_u24 v5, 52429, v4
    v_lshrrev_b32 v5, 21, v5
    v_mul_u32_u24 v5, 40, v5
    v_sub_u32 v4, v4, v5
    v_cvt_f32_u32 v4, v4
    v_mul_f32 v244, 0x3ccccccd, v4
    v_mul_u32_u24 v5, 6554, v3
    v_lshrrev_b32 v5, 16, v5
    v_mul_u32_u24 v5, 10, v5
    v_sub_u32 v4, v3, v5
    v_cvt_f32_u32 v4, v4
    v_mul_f32 v246, 0x3dcccccd, v4
    v_mul_f32 v4, 0x3acccccd, v6
    v_mul_f32 v5, 0x3b4ccccd, v6
    v_mul_f32 v6, 0x3b99999a, v6
    v_cos_f32 v228, v4
    v_sin_f32 v229, v4
    v_cos_f32 v224, v5
    v_sin_f32 v226, v5
    v_cos_f32 v225, v6
    v_sin_f32 v227, v6
    v_add_u32 v3, s60, v1
    s_add_u32 s60, s60, 16
    v_cmp_ge_u32 vcc, 80, v3
    s_nop 1
    v_cndmask_b32 v3, 0, v3, vcc
    v_cvt_f32_u32 v6, v3
    v_mul_f32 v249, 0x3bcccccd, v6
    v_mul_u32_u24 v4, v8, v3
    v_mul_u32_u24 v5, 52429, v4
    v_lshrrev_b32 v5, 21, v5
    v_mul_u32_u24 v5, 40, v5
    v_sub_u32 v4, v4, v5
    v_cvt_f32_u32 v4, v4
    v_mul_f32 v245, 0x3ccccccd, v4
    v_mul_u32_u24 v5, 6554, v3
    v_lshrrev_b32 v5, 16, v5
    v_mul_u32_u24 v5, 10, v5
    v_sub_u32 v4, v3, v5
    v_cvt_f32_u32 v4, v4
    v_mul_f32 v247, 0x3dcccccd, v4
    v_mul_f32 v4, 0x3acccccd, v6
    v_mul_f32 v5, 0x3b4ccccd, v6
    v_mul_f32 v6, 0x3b99999a, v6
    v_cos_f32 v234, v4
    v_sin_f32 v235, v4
    v_cos_f32 v230, v5
    v_sin_f32 v232, v5
    v_cos_f32 v231, v6
    v_sin_f32 v233, v6
    v_add_f32 v237, v244, v248
    v_cos_f32 v240, v244
    v_sin_f32 v236, v244
    v_add_f32 v244, v244, v246
    v_add_f32 v238, v237, v248
    v_cos_f32 v241, v237
    v_sin_f32 v237, v237
    v_add_f32 v239, v238, v248
    v_cos_f32 v242, v238
    v_sin_f32 v238, v238
    v_cos_f32 v243, v239
    v_sin_f32 v239, v239
    v_fract_f32 v244, v244
    v_cvt_pk_bf16_f32 v160, v240, v241
    v_cvt_pk_bf16_f32 v161, v242, v243
    v_cvt_pk_bf16_f32 v164, v236, v237
    v_cvt_pk_bf16_f32 v165, v238, v239
    v_xor_b32 v162, v160, v250
    v_xor_b32 v163, v161, v250
    v_xor_b32 v166, v164, v250
    v_xor_b32 v167, v165, v250
    v_add_f32 v237, v245, v249
    v_cos_f32 v240, v245
    v_sin_f32 v236, v245
    v_add_f32 v245, v245, v247
    v_add_f32 v238, v237, v249
    v_cos_f32 v241, v237
    v_sin_f32 v237, v237
    v_add_f32 v239, v238, v249
    v_cos_f32 v242, v238
    v_sin_f32 v238, v238
    v_cos_f32 v243, v239
    v_sin_f32 v239, v239
    v_fract_f32 v245, v245
    v_cvt_pk_bf16_f32 v168, v240, v241
    v_cvt_pk_bf16_f32 v169, v242, v243
    v_cvt_pk_bf16_f32 v172, v236, v237
    v_cvt_pk_bf16_f32 v173, v238, v239
    v_xor_b32 v170, v168, v250
    v_xor_b32 v171, v169, v250
    v_xor_b32 v174, v172, v250
    v_xor_b32 v175, v173, v250
    v_lshrrev_b32 v3, 1, v1
    v_and_b32 v4, 1, v1
    v_cvt_f32_u32 v4, v4
    v_mul_f32 v4, 0xbe800000, v4
    v_lshlrev_b32 v5, 3, v2
    v_add_u32 v6, 0, v3
    v_cmp_eq_u32 vcc, 1, v1
    s_nop 1
    v_cndmask_b32 v6, v6, 32, vcc
    v_cndmask_b32 v9, v4, 0, vcc
    v_cvt_f32_u32 v7, v6
    v_mul_f32 v7, 0x3c800000, v7
    v_mul_u32_u24 v8, v5, v6
    v_and_b32 v8, 63, v8
    v_cvt_f32_u32 v8, v8
    v_mul_f32 v8, 0x3c800000, v8
    v_add_f32 v236, v8, v9
    v_add_f32 v237, v236, v7
    v_add_f32 v238, v237, v7
    v_add_f32 v239, v238, v7
    v_add_f32 v240, v239, v7
    v_add_f32 v241, v240, v7
    v_add_f32 v242, v241, v7
    v_add_f32 v243, v242, v7
    v_cos_f32 v236, v236
    v_cos_f32 v237, v237
    v_cos_f32 v238, v238
    v_cos_f32 v239, v239
    v_cos_f32 v240, v240
    v_cos_f32 v241, v241
    v_cos_f32 v242, v242
    v_cos_f32 v243, v243
    v_and_b32 v8, 1, v6
    v_mul_u32_u24 v8, 0x8000, v8
    v_lshl_add_u32 v8, v8, 16, v8
    v_cvt_pk_bf16_f32 v192, v236, v237
    v_cvt_pk_bf16_f32 v193, v238, v239
    v_cvt_pk_bf16_f32 v194, v240, v241
    v_cvt_pk_bf16_f32 v195, v242, v243
    v_xor_b32 v196, v192, v8
    v_xor_b32 v197, v193, v8
    v_xor_b32 v198, v194, v8
    v_xor_b32 v199, v195, v8
    v_add_u32 v6, 8, v3
    v_mov_b32 v9, v4
    v_cvt_f32_u32 v7, v6
    v_mul_f32 v7, 0x3c800000, v7
    v_mul_u32_u24 v8, v5, v6
    v_and_b32 v8, 63, v8
    v_cvt_f32_u32 v8, v8
    v_mul_f32 v8, 0x3c800000, v8
    v_add_f32 v236, v8, v9
    v_add_f32 v237, v236, v7
    v_add_f32 v238, v237, v7
    v_add_f32 v239, v238, v7
    v_add_f32 v240, v239, v7
    v_add_f32 v241, v240, v7
    v_add_f32 v242, v241, v7
    v_add_f32 v243, v242, v7
    v_cos_f32 v236, v236
    v_cos_f32 v237, v237
    v_cos_f32 v238, v238
    v_cos_f32 v239, v239
    v_cos_f32 v240, v240
    v_cos_f32 v241, v241
    v_cos_f32 v242, v242
    v_cos_f32 v243, v243
    v_and_b32 v8, 1, v6
    v_mul_u32_u24 v8, 0x8000, v8
    v_lshl_add_u32 v8, v8, 16, v8
    v_cvt_pk_bf16_f32 v200, v236, v237
    v_cvt_pk_bf16_f32 v201, v238, v239
    v_cvt_pk_bf16_f32 v202, v240, v241
    v_cvt_pk_bf16_f32 v203, v242, v243
    v_xor_b32 v204, v200, v8
    v_xor_b32 v205, v201, v8
    v_xor_b32 v206, v202, v8
    v_xor_b32 v207, v203, v8
    v_add_u32 v6, 16, v3
    v_mov_b32 v9, v4
    v_cvt_f32_u32 v7, v6
    v_mul_f32 v7, 0x3c800000, v7
    v_mul_u32_u24 v8, v5, v6
    v_and_b32 v8, 63, v8
    v_cvt_f32_u32 v8, v8
    v_mul_f32 v8, 0x3c800000, v8
    v_add_f32 v236, v8, v9
    v_add_f32 v237, v236, v7
    v_add_f32 v238, v237, v7
    v_add_f32 v239, v238, v7
    v_add_f32 v240, v239, v7
    v_add_f32 v241, v240, v7
    v_add_f32 v242, v241, v7
    v_add_f32 v243, v242, v7
    v_cos_f32 v236, v236
    v_cos_f32 v237, v237
    v_cos_f32 v238, v238
    v_cos_f32 v239, v239
    v_cos_f32 v240, v240
    v_cos_f32 v241, v241
    v_cos_f32 v242, v242
    v_cos_f32 v243, v243
    v_and_b32 v8, 1, v6
    v_mul_u32_u24 v8, 0x8000, v8
    v_lshl_add_u32 v8, v8, 16, v8
    v_cvt_pk_bf16_f32 v208, v236, v237
    v_cvt_pk_bf16_f32 v209, v238, v239
    v_cvt_pk_bf16_f32 v210, v240, v241
    v_cvt_pk_bf16_f32 v211, v242, v243
    v_xor_b32 v212, v208, v8
    v_xor_b32 v213, v209, v8
    v_xor_b32 v214, v210, v8
    v_xor_b32 v215, v211, v8
    v_add_u32 v6, 24, v3
    v_mov_b32 v9, v4
    v_cvt_f32_u32 v7, v6
    v_mul_f32 v7, 0x3c800000, v7
    v_mul_u32_u24 v8, v5, v6
    v_and_b32 v8, 63, v8
    v_cvt_f32_u32 v8, v8
    v_mul_f32 v8, 0x3c800000, v8
    v_add_f32 v236, v8, v9
    v_add_f32 v237, v236, v7
    v_add_f32 v238, v237, v7
    v_add_f32 v239, v238, v7
    v_add_f32 v240, v239, v7
    v_add_f32 v241, v240, v7
    v_add_f32 v242, v241, v7
    v_add_f32 v243, v242, v7
    v_cos_f32 v236, v236
    v_cos_f32 v237, v237
    v_cos_f32 v238, v238
    v_cos_f32 v239, v239
    v_cos_f32 v240, v240
    v_cos_f32 v241, v241
    v_cos_f32 v242, v242
    v_cos_f32 v243, v243
    v_and_b32 v8, 1, v6
    v_mul_u32_u24 v8, 0x8000, v8
    v_lshl_add_u32 v8, v8, 16, v8
    v_cvt_pk_bf16_f32 v216, v236, v237
    v_cvt_pk_bf16_f32 v217, v238, v239
    v_cvt_pk_bf16_f32 v218, v240, v241
    v_cvt_pk_bf16_f32 v219, v242, v243
    v_xor_b32 v220, v216, v8
    v_xor_b32 v221, v217, v8
    v_xor_b32 v222, v218, v8
    v_xor_b32 v223, v219, v8
    s_waitcnt lgkmcnt(0)
    s_add_u32 s20, s50, 2621440
    s_addc_u32 s21, s51, 0
    s_mov_b32 s22, 2883584
    s_mov_b32 s23, 0x20000
    s_add_u32 s52, s62, 0
    s_add_u32 s53, s62, 90112
    s_add_u32 s54, s62, 720896
    s_add_u32 s55, s62, 811008
    s_add_u32 s56, s62, 1441792
    s_add_u32 s57, s62, 1531904
    s_add_u32 s58, s62, 2162688
    s_add_u32 s59, s62, 2252800
.p2align 3
    s_barrier
    ds_read_b64_tr_b16 v[128:129], v251 offset:0
    ds_read_b64_tr_b16 v[130:131], v251 offset:4096
    ds_read_b64_tr_b16 v[132:133], v251 offset:512
    ds_read_b64_tr_b16 v[134:135], v251 offset:4608
    ds_read_b64_tr_b16 v[136:137], v251 offset:1024
    ds_read_b64_tr_b16 v[138:139], v251 offset:5120
    s_waitcnt lgkmcnt(4)
    v_mfma_f32_16x16x32_bf16 v[0:3], v[128:131], v[160:163], 0
    ds_read_b64_tr_b16 v[140:141], v251 offset:1536
    v_add_f32_e64 v237, v244, v248
    v_mfma_f32_16x16x32_bf16 v[4:7], v[128:131], v[164:167], 0
    ds_read_b64_tr_b16 v[142:143], v251 offset:5632
    v_cos_f32_e64 v240, v244
    v_mfma_f32_16x16x32_bf16 v[8:11], v[128:131], v[168:171], 0
    v_sin_f32_e64 v236, v244
    v_mfma_f32_16x16x32_bf16 v[12:15], v[128:131], v[172:175], 0
    v_add_f32 v244, v244, v246
    v_add_f32_e64 v238, v237, v248
    s_waitcnt lgkmcnt(4)
    v_mfma_f32_16x16x32_bf16 v[16:19], v[132:135], v[160:163], 0
    ds_read_b64_tr_b16 v[144:145], v251 offset:2048
    v_cos_f32_e64 v241, v237
    v_mfma_f32_16x16x32_bf16 v[20:23], v[132:135], v[164:167], 0
    ds_read_b64_tr_b16 v[146:147], v251 offset:6144
    v_mfma_f32_16x16x32_bf16 v[24:27], v[132:135], v[168:171], 0
    v_sin_f32 v237, v237
    v_add_f32 v239, v238, v248
    v_mfma_f32_16x16x32_bf16 v[28:31], v[132:135], v[172:175], 0
    v_cos_f32 v242, v238
    v_sin_f32_e64 v238, v238
    s_waitcnt lgkmcnt(4)
    v_mfma_f32_16x16x32_bf16 v[32:35], v[136:139], v[160:163], 0
    ds_read_b64_tr_b16 v[148:149], v251 offset:2560
    v_mfma_f32_16x16x32_bf16 v[36:39], v[136:139], v[164:167], 0
    ds_read_b64_tr_b16 v[150:151], v251 offset:6656
    v_cos_f32_e64 v243, v239
    v_mfma_f32_16x16x32_bf16 v[40:43], v[136:139], v[168:171], 0
    v_sin_f32_e64 v239, v239
    v_mfma_f32_16x16x32_bf16 v[44:47], v[136:139], v[172:175], 0
    v_fract_f32_e64 v244, v244
    v_cvt_pk_bf16_f32 v176, v240, v241
    v_cvt_pk_bf16_f32 v177, v242, v243
    s_waitcnt lgkmcnt(4)
    v_mfma_f32_16x16x32_bf16 v[48:51], v[140:143], v[160:163], 0
    ds_read_b64_tr_b16 v[152:153], v251 offset:3072
    v_mfma_f32_16x16x32_bf16 v[52:55], v[140:143], v[164:167], 0
    ds_read_b64_tr_b16 v[154:155], v251 offset:7168
    v_cvt_pk_bf16_f32 v180, v236, v237
    v_cvt_pk_bf16_f32 v181, v238, v239
    v_mfma_f32_16x16x32_bf16 v[56:59], v[140:143], v[168:171], 0
    v_xor_b32 v178, v176, v250
    v_xor_b32 v179, v177, v250
    v_xor_b32 v182, v180, v250
    v_mfma_f32_16x16x32_bf16 v[60:63], v[140:143], v[172:175], 0
    v_xor_b32 v183, v181, v250
    v_add_f32_e64 v237, v245, v249
    s_waitcnt lgkmcnt(4)
    v_mfma_f32_16x16x32_bf16 v[64:67], v[144:147], v[160:163], 0
    ds_read_b64_tr_b16 v[156:157], v251 offset:3584
    v_mfma_f32_16x16x32_bf16 v[68:71], v[144:147], v[164:167], 0
    ds_read_b64_tr_b16 v[158:159], v251 offset:7680
    v_cos_f32_e64 v240, v245
    v_mfma_f32_16x16x32_bf16 v[72:75], v[144:147], v[168:171], 0
    v_sin_f32 v236, v245
    v_add_f32 v245, v245, v247
    v_mfma_f32_16x16x32_bf16 v[76:79], v[144:147], v[172:175], 0
    v_add_f32 v238, v237, v249
    v_cos_f32 v241, v237
    s_waitcnt lgkmcnt(0)
    s_barrier
    v_mfma_f32_16x16x32_bf16 v[80:83], v[148:151], v[160:163], 0
    ds_read_b64_tr_b16 v[128:129], v251 offset:8192
    v_mfma_f32_16x16x32_bf16 v[84:87], v[148:151], v[164:167], 0
    ds_read_b64_tr_b16 v[130:131], v251 offset:12288
    v_sin_f32_e64 v237, v237
    v_mfma_f32_16x16x32_bf16 v[88:91], v[148:151], v[168:171], 0
    v_add_f32 v239, v238, v249
    v_cos_f32 v242, v238
    v_mfma_f32_16x16x32_bf16 v[92:95], v[148:151], v[172:175], 0
    v_sin_f32 v238, v238
    s_waitcnt lgkmcnt(4)
    v_mfma_f32_16x16x32_bf16 v[96:99], v[152:155], v[160:163], 0
    ds_read_b64_tr_b16 v[132:133], v251 offset:8704
    v_cos_f32_e64 v243, v239
    v_mfma_f32_16x16x32_bf16 v[100:103], v[152:155], v[164:167], 0
    ds_read_b64_tr_b16 v[134:135], v251 offset:12800
    v_mfma_f32_16x16x32_bf16 v[104:107], v[152:155], v[168:171], 0
    v_sin_f32 v239, v239
    v_fract_f32 v245, v245
    v_mfma_f32_16x16x32_bf16 v[108:111], v[152:155], v[172:175], 0
    v_cvt_pk_bf16_f32 v184, v240, v241
    v_cvt_pk_bf16_f32 v185, v242, v243
    v_cvt_pk_bf16_f32 v188, v236, v237
    s_waitcnt lgkmcnt(4)
    v_mfma_f32_16x16x32_bf16 v[112:115], v[156:159], v[160:163], 0
    ds_read_b64_tr_b16 v[136:137], v251 offset:9216
    v_cvt_pk_bf16_f32 v189, v238, v239
    v_mfma_f32_16x16x32_bf16 v[116:119], v[156:159], v[164:167], 0
    ds_read_b64_tr_b16 v[138:139], v251 offset:13312
    v_xor_b32 v186, v184, v250
    v_mfma_f32_16x16x32_bf16 v[120:123], v[156:159], v[168:171], 0
    v_xor_b32 v187, v185, v250
    v_xor_b32 v190, v188, v250
    v_xor_b32_e64 v191, v189, v250
    v_mfma_f32_16x16x32_bf16 v[124:127], v[156:159], v[172:175], 0
    s_waitcnt lgkmcnt(4)
    v_mfma_f32_16x16x32_bf16 v[0:3], v[128:131], v[176:179], v[0:3]
    ds_read_b64_tr_b16 v[140:141], v251 offset:9728
    v_add_f32 v237, v244, v248
    v_mfma_f32_16x16x32_bf16 v[4:7], v[128:131], v[180:183], v[4:7]
    ds_read_b64_tr_b16 v[142:143], v251 offset:13824
    v_cos_f32_e64 v240, v244
    v_mfma_f32_16x16x32_bf16 v[8:11], v[128:131], v[184:187], v[8:11]
    v_sin_f32_e64 v236, v244
    v_mfma_f32_16x16x32_bf16 v[12:15], v[128:131], v[188:191], v[12:15]
    v_add_f32 v244, v244, v246
    v_add_f32_e64 v238, v237, v248
    s_waitcnt lgkmcnt(4)
    v_mfma_f32_16x16x32_bf16 v[16:19], v[132:135], v[176:179], v[16:19]
    ds_read_b64_tr_b16 v[144:145], v251 offset:10240
    v_cos_f32_e64 v241, v237
    v_mfma_f32_16x16x32_bf16 v[20:23], v[132:135], v[180:183], v[20:23]
    ds_read_b64_tr_b16 v[146:147], v251 offset:14336
    v_mfma_f32_16x16x32_bf16 v[24:27], v[132:135], v[184:187], v[24:27]
    v_sin_f32 v237, v237
    v_add_f32 v239, v238, v248
    v_mfma_f32_16x16x32_bf16 v[28:31], v[132:135], v[188:191], v[28:31]
    v_cos_f32 v242, v238
    v_sin_f32_e64 v238, v238
    s_waitcnt lgkmcnt(4)
    v_mfma_f32_16x16x32_bf16 v[32:35], v[136:139], v[176:179], v[32:35]
    ds_read_b64_tr_b16 v[148:149], v251 offset:10752
    v_mfma_f32_16x16x32_bf16 v[36:39], v[136:139], v[180:183], v[36:39]
    ds_read_b64_tr_b16 v[150:151], v251 offset:14848
    v_cos_f32_e64 v243, v239
    v_mfma_f32_16x16x32_bf16 v[40:43], v[136:139], v[184:187], v[40:43]
    v_sin_f32_e64 v239, v239
    v_mfma_f32_16x16x32_bf16 v[44:47], v[136:139], v[188:191], v[44:47]
    v_fract_f32_e64 v244, v244
    v_cvt_pk_bf16_f32 v160, v240, v241
    v_cvt_pk_bf16_f32 v161, v242, v243
    s_waitcnt lgkmcnt(4)
    v_mfma_f32_16x16x32_bf16 v[48:51], v[140:143], v[176:179], v[48:51]
    ds_read_b64_tr_b16 v[152:153], v251 offset:11264
    v_mfma_f32_16x16x32_bf16 v[52:55], v[140:143], v[180:183], v[52:55]
    ds_read_b64_tr_b16 v[154:155], v251 offset:15360
    v_cvt_pk_bf16_f32 v164, v236, v237
    v_cvt_pk_bf16_f32 v165, v238, v239
    v_mfma_f32_16x16x32_bf16 v[56:59], v[140:143], v[184:187], v[56:59]
    v_xor_b32 v162, v160, v250
    v_xor_b32 v163, v161, v250
    v_xor_b32 v166, v164, v250
    v_mfma_f32_16x16x32_bf16 v[60:63], v[140:143], v[188:191], v[60:63]
    v_xor_b32 v167, v165, v250
    v_add_f32_e64 v237, v245, v249
    s_waitcnt lgkmcnt(4)
    v_mfma_f32_16x16x32_bf16 v[64:67], v[144:147], v[176:179], v[64:67]
    ds_read_b64_tr_b16 v[156:157], v251 offset:11776
    v_mfma_f32_16x16x32_bf16 v[68:71], v[144:147], v[180:183], v[68:71]
    ds_read_b64_tr_b16 v[158:159], v251 offset:15872
    v_cos_f32_e64 v240, v245
    v_mfma_f32_16x16x32_bf16 v[72:75], v[144:147], v[184:187], v[72:75]
    v_sin_f32 v236, v245
    v_add_f32 v245, v245, v247
    v_mfma_f32_16x16x32_bf16 v[76:79], v[144:147], v[188:191], v[76:79]
    v_add_f32 v238, v237, v249
    v_cos_f32 v241, v237
    s_waitcnt lgkmcnt(0)
    s_barrier
    v_mfma_f32_16x16x32_bf16 v[80:83], v[148:151], v[176:179], v[80:83]
    ds_read_b64_tr_b16 v[128:129], v251 offset:16384
    v_mfma_f32_16x16x32_bf16 v[84:87], v[148:151], v[180:183], v[84:87]
    ds_read_b64_tr_b16 v[130:131], v251 offset:20480
    v_sin_f32_e64 v237, v237
    v_mfma_f32_16x16x32_bf16 v[88:91], v[148:151], v[184:187], v[88:91]
    v_add_f32 v239, v238, v249
    v_cos_f32 v242, v238
    v_mfma_f32_16x16x32_bf16 v[92:95], v[148:151], v[188:191], v[92:95]
    v_sin_f32 v238, v238
    s_waitcnt lgkmcnt(4)
    v_mfma_f32_16x16x32_bf16 v[96:99], v[152:155], v[176:179], v[96:99]
    ds_read_b64_tr_b16 v[132:133], v251 offset:16896
    v_cos_f32_e64 v243, v239
    v_mfma_f32_16x16x32_bf16 v[100:103], v[152:155], v[180:183], v[100:103]
    ds_read_b64_tr_b16 v[134:135], v251 offset:20992
    v_mfma_f32_16x16x32_bf16 v[104:107], v[152:155], v[184:187], v[104:107]
    v_sin_f32 v239, v239
    v_fract_f32 v245, v245
    v_mfma_f32_16x16x32_bf16 v[108:111], v[152:155], v[188:191], v[108:111]
    v_cvt_pk_bf16_f32 v168, v240, v241
    v_cvt_pk_bf16_f32 v169, v242, v243
    v_cvt_pk_bf16_f32 v172, v236, v237
    s_waitcnt lgkmcnt(4)
    v_mfma_f32_16x16x32_bf16 v[112:115], v[156:159], v[176:179], v[112:115]
    ds_read_b64_tr_b16 v[136:137], v251 offset:17408
    v_cvt_pk_bf16_f32 v173, v238, v239
    v_mfma_f32_16x16x32_bf16 v[116:119], v[156:159], v[180:183], v[116:119]
    ds_read_b64_tr_b16 v[138:139], v251 offset:21504
    v_xor_b32 v170, v168, v250
    v_mfma_f32_16x16x32_bf16 v[120:123], v[156:159], v[184:187], v[120:123]
    v_xor_b32 v171, v169, v250
    v_xor_b32 v174, v172, v250
    v_xor_b32_e64 v175, v173, v250
    v_mfma_f32_16x16x32_bf16 v[124:127], v[156:159], v[188:191], v[124:127]
    s_waitcnt lgkmcnt(4)
    v_mfma_f32_16x16x32_bf16 v[0:3], v[128:131], v[160:163], v[0:3]
    ds_read_b64_tr_b16 v[140:141], v251 offset:17920
    v_add_f32 v237, v244, v248
    v_mfma_f32_16x16x32_bf16 v[4:7], v[128:131], v[164:167], v[4:7]
    ds_read_b64_tr_b16 v[142:143], v251 offset:22016
    v_cos_f32_e64 v240, v244
    v_mfma_f32_16x16x32_bf16 v[8:11], v[128:131], v[168:171], v[8:11]
    v_sin_f32_e64 v236, v244
    v_mfma_f32_16x16x32_bf16 v[12:15], v[128:131], v[172:175], v[12:15]
    v_add_f32 v244, v244, v246
    v_add_f32_e64 v238, v237, v248
    s_waitcnt lgkmcnt(4)
    v_mfma_f32_16x16x32_bf16 v[16:19], v[132:135], v[160:163], v[16:19]
    ds_read_b64_tr_b16 v[144:145], v251 offset:18432
    v_cos_f32_e64 v241, v237
    v_mfma_f32_16x16x32_bf16 v[20:23], v[132:135], v[164:167], v[20:23]
    ds_read_b64_tr_b16 v[146:147], v251 offset:22528
    v_mfma_f32_16x16x32_bf16 v[24:27], v[132:135], v[168:171], v[24:27]
    v_sin_f32 v237, v237
    v_add_f32 v239, v238, v248
    v_mfma_f32_16x16x32_bf16 v[28:31], v[132:135], v[172:175], v[28:31]
    v_cos_f32 v242, v238
    v_sin_f32_e64 v238, v238
    s_waitcnt lgkmcnt(4)
    v_mfma_f32_16x16x32_bf16 v[32:35], v[136:139], v[160:163], v[32:35]
    ds_read_b64_tr_b16 v[148:149], v251 offset:18944
    v_mfma_f32_16x16x32_bf16 v[36:39], v[136:139], v[164:167], v[36:39]
    ds_read_b64_tr_b16 v[150:151], v251 offset:23040
    v_cos_f32_e64 v243, v239
    v_mfma_f32_16x16x32_bf16 v[40:43], v[136:139], v[168:171], v[40:43]
    v_sin_f32_e64 v239, v239
    v_mfma_f32_16x16x32_bf16 v[44:47], v[136:139], v[172:175], v[44:47]
    v_fract_f32_e64 v244, v244
    v_cvt_pk_bf16_f32 v176, v240, v241
    v_cvt_pk_bf16_f32 v177, v242, v243
    s_waitcnt lgkmcnt(4)
    v_mfma_f32_16x16x32_bf16 v[48:51], v[140:143], v[160:163], v[48:51]
    ds_read_b64_tr_b16 v[152:153], v251 offset:19456
    v_mfma_f32_16x16x32_bf16 v[52:55], v[140:143], v[164:167], v[52:55]
    ds_read_b64_tr_b16 v[154:155], v251 offset:23552
    v_cvt_pk_bf16_f32 v180, v236, v237
    v_cvt_pk_bf16_f32 v181, v238, v239
    v_mfma_f32_16x16x32_bf16 v[56:59], v[140:143], v[168:171], v[56:59]
    v_xor_b32 v178, v176, v250
    v_xor_b32 v179, v177, v250
    v_xor_b32 v182, v180, v250
    v_mfma_f32_16x16x32_bf16 v[60:63], v[140:143], v[172:175], v[60:63]
    v_xor_b32 v183, v181, v250
    v_add_f32_e64 v237, v245, v249
    s_waitcnt lgkmcnt(4)
    v_mfma_f32_16x16x32_bf16 v[64:67], v[144:147], v[160:163], v[64:67]
    ds_read_b64_tr_b16 v[156:157], v251 offset:19968
    v_mfma_f32_16x16x32_bf16 v[68:71], v[144:147], v[164:167], v[68:71]
    ds_read_b64_tr_b16 v[158:159], v251 offset:24064
    v_cos_f32_e64 v240, v245
    v_mfma_f32_16x16x32_bf16 v[72:75], v[144:147], v[168:171], v[72:75]
    v_sin_f32 v236, v245
    v_add_f32 v245, v245, v247
    v_mfma_f32_16x16x32_bf16 v[76:79], v[144:147], v[172:175], v[76:79]
    v_add_f32 v238, v237, v249
    v_cos_f32 v241, v237
    s_waitcnt lgkmcnt(0)
    s_barrier
    v_mfma_f32_16x16x32_bf16 v[80:83], v[148:151], v[160:163], v[80:83]
    ds_read_b64_tr_b16 v[128:129], v251 offset:0
    v_mfma_f32_16x16x32_bf16 v[84:87], v[148:151], v[164:167], v[84:87]
    ds_read_b64_tr_b16 v[130:131], v251 offset:4096
    v_sin_f32_e64 v237, v237
    v_mfma_f32_16x16x32_bf16 v[88:91], v[148:151], v[168:171], v[88:91]
    v_add_f32 v239, v238, v249
    v_cos_f32 v242, v238
    v_mfma_f32_16x16x32_bf16 v[92:95], v[148:151], v[172:175], v[92:95]
    v_sin_f32 v238, v238
    s_waitcnt lgkmcnt(4)
    v_mfma_f32_16x16x32_bf16 v[96:99], v[152:155], v[160:163], v[96:99]
    ds_read_b64_tr_b16 v[132:133], v251 offset:512
    v_cos_f32_e64 v243, v239
    v_mfma_f32_16x16x32_bf16 v[100:103], v[152:155], v[164:167], v[100:103]
    ds_read_b64_tr_b16 v[134:135], v251 offset:4608
    v_mfma_f32_16x16x32_bf16 v[104:107], v[152:155], v[168:171], v[104:107]
    v_sin_f32 v239, v239
    v_fract_f32 v245, v245
    v_mfma_f32_16x16x32_bf16 v[108:111], v[152:155], v[172:175], v[108:111]
    v_cvt_pk_bf16_f32 v184, v240, v241
    v_cvt_pk_bf16_f32 v185, v242, v243
    v_cvt_pk_bf16_f32 v188, v236, v237
    s_waitcnt lgkmcnt(4)
    v_mfma_f32_16x16x32_bf16 v[112:115], v[156:159], v[160:163], v[112:115]
    ds_read_b64_tr_b16 v[136:137], v251 offset:1024
    v_cvt_pk_bf16_f32 v189, v238, v239
    v_mfma_f32_16x16x32_bf16 v[116:119], v[156:159], v[164:167], v[116:119]
    ds_read_b64_tr_b16 v[138:139], v251 offset:5120
    v_xor_b32 v186, v184, v250
    v_mfma_f32_16x16x32_bf16 v[120:123], v[156:159], v[168:171], v[120:123]
    v_xor_b32 v187, v185, v250
    v_xor_b32 v190, v188, v250
    v_xor_b32_e64 v191, v189, v250
    v_mfma_f32_16x16x32_bf16 v[124:127], v[156:159], v[172:175], v[124:127]
    s_waitcnt lgkmcnt(4)
    v_mfma_f32_16x16x32_bf16 v[0:3], v[128:131], v[176:179], v[0:3]
    ds_read_b64_tr_b16 v[140:141], v251 offset:1536
    v_add_f32 v237, v244, v248
    v_mfma_f32_16x16x32_bf16 v[4:7], v[128:131], v[180:183], v[4:7]
    ds_read_b64_tr_b16 v[142:143], v251 offset:5632
    v_cos_f32_e64 v240, v244
    v_mfma_f32_16x16x32_bf16 v[8:11], v[128:131], v[184:187], v[8:11]
    v_sin_f32_e64 v236, v244
    v_mfma_f32_16x16x32_bf16 v[12:15], v[128:131], v[188:191], v[12:15]
    v_add_f32 v244, v244, v246
    v_add_f32_e64 v238, v237, v248
    s_waitcnt lgkmcnt(4)
    v_mfma_f32_16x16x32_bf16 v[16:19], v[132:135], v[176:179], v[16:19]
    ds_read_b64_tr_b16 v[144:145], v251 offset:2048
    v_cos_f32_e64 v241, v237
    v_mfma_f32_16x16x32_bf16 v[20:23], v[132:135], v[180:183], v[20:23]
    ds_read_b64_tr_b16 v[146:147], v251 offset:6144
    v_mfma_f32_16x16x32_bf16 v[24:27], v[132:135], v[184:187], v[24:27]
    v_sin_f32 v237, v237
    v_add_f32 v239, v238, v248
    v_mfma_f32_16x16x32_bf16 v[28:31], v[132:135], v[188:191], v[28:31]
    v_cos_f32 v242, v238
    v_sin_f32_e64 v238, v238
    s_waitcnt lgkmcnt(4)
    v_mfma_f32_16x16x32_bf16 v[32:35], v[136:139], v[176:179], v[32:35]
    ds_read_b64_tr_b16 v[148:149], v251 offset:2560
    v_mfma_f32_16x16x32_bf16 v[36:39], v[136:139], v[180:183], v[36:39]
    ds_read_b64_tr_b16 v[150:151], v251 offset:6656
    v_cos_f32_e64 v243, v239
    v_mfma_f32_16x16x32_bf16 v[40:43], v[136:139], v[184:187], v[40:43]
    v_sin_f32_e64 v239, v239
    v_mfma_f32_16x16x32_bf16 v[44:47], v[136:139], v[188:191], v[44:47]
    v_fract_f32_e64 v244, v244
    v_cvt_pk_bf16_f32 v160, v240, v241
    v_cvt_pk_bf16_f32 v161, v242, v243
    s_waitcnt lgkmcnt(4)
    v_mfma_f32_16x16x32_bf16 v[48:51], v[140:143], v[176:179], v[48:51]
    ds_read_b64_tr_b16 v[152:153], v251 offset:3072
    v_mfma_f32_16x16x32_bf16 v[52:55], v[140:143], v[180:183], v[52:55]
    ds_read_b64_tr_b16 v[154:155], v251 offset:7168
    v_cvt_pk_bf16_f32 v164, v236, v237
    v_cvt_pk_bf16_f32 v165, v238, v239
    v_mfma_f32_16x16x32_bf16 v[56:59], v[140:143], v[184:187], v[56:59]
    v_xor_b32 v162, v160, v250
    v_xor_b32 v163, v161, v250
    v_xor_b32 v166, v164, v250
    v_mfma_f32_16x16x32_bf16 v[60:63], v[140:143], v[188:191], v[60:63]
    v_xor_b32 v167, v165, v250
    v_add_f32_e64 v237, v245, v249
    s_waitcnt lgkmcnt(4)
    v_mfma_f32_16x16x32_bf16 v[64:67], v[144:147], v[176:179], v[64:67]
    ds_read_b64_tr_b16 v[156:157], v251 offset:3584
    v_mfma_f32_16x16x32_bf16 v[68:71], v[144:147], v[180:183], v[68:71]
    ds_read_b64_tr_b16 v[158:159], v251 offset:7680
    v_cos_f32_e64 v240, v245
    v_mfma_f32_16x16x32_bf16 v[72:75], v[144:147], v[184:187], v[72:75]
    v_sin_f32 v236, v245
    v_add_f32 v245, v245, v247
    v_mfma_f32_16x16x32_bf16 v[76:79], v[144:147], v[188:191], v[76:79]
    v_add_f32 v238, v237, v249
    v_cos_f32 v241, v237
    s_waitcnt lgkmcnt(0)
    s_barrier
    v_mfma_f32_16x16x32_bf16 v[80:83], v[148:151], v[176:179], v[80:83]
    ds_read_b64_tr_b16 v[128:129], v251 offset:8192
    v_mfma_f32_16x16x32_bf16 v[84:87], v[148:151], v[180:183], v[84:87]
    ds_read_b64_tr_b16 v[130:131], v251 offset:12288
    v_sin_f32_e64 v237, v237
    v_mfma_f32_16x16x32_bf16 v[88:91], v[148:151], v[184:187], v[88:91]
    v_add_f32 v239, v238, v249
    v_cos_f32 v242, v238
    v_mfma_f32_16x16x32_bf16 v[92:95], v[148:151], v[188:191], v[92:95]
    v_sin_f32 v238, v238
    s_waitcnt lgkmcnt(4)
    v_mfma_f32_16x16x32_bf16 v[96:99], v[152:155], v[176:179], v[96:99]
    ds_read_b64_tr_b16 v[132:133], v251 offset:8704
    v_cos_f32_e64 v243, v239
    v_mfma_f32_16x16x32_bf16 v[100:103], v[152:155], v[180:183], v[100:103]
    ds_read_b64_tr_b16 v[134:135], v251 offset:12800
    v_mfma_f32_16x16x32_bf16 v[104:107], v[152:155], v[184:187], v[104:107]
    v_sin_f32 v239, v239
    v_fract_f32 v245, v245
    v_mfma_f32_16x16x32_bf16 v[108:111], v[152:155], v[188:191], v[108:111]
    v_cvt_pk_bf16_f32 v168, v240, v241
    v_cvt_pk_bf16_f32 v169, v242, v243
    v_cvt_pk_bf16_f32 v172, v236, v237
    s_waitcnt lgkmcnt(4)
    v_mfma_f32_16x16x32_bf16 v[112:115], v[156:159], v[176:179], v[112:115]
    ds_read_b64_tr_b16 v[136:137], v251 offset:9216
    v_cvt_pk_bf16_f32 v173, v238, v239
    v_mfma_f32_16x16x32_bf16 v[116:119], v[156:159], v[180:183], v[116:119]
    ds_read_b64_tr_b16 v[138:139], v251 offset:13312
    v_xor_b32 v170, v168, v250
    v_mfma_f32_16x16x32_bf16 v[120:123], v[156:159], v[184:187], v[120:123]
    v_xor_b32 v171, v169, v250
    v_xor_b32 v174, v172, v250
    v_xor_b32_e64 v175, v173, v250
    v_mfma_f32_16x16x32_bf16 v[124:127], v[156:159], v[188:191], v[124:127]
    s_waitcnt lgkmcnt(4)
    v_mfma_f32_16x16x32_bf16 v[0:3], v[128:131], v[160:163], v[0:3]
    ds_read_b64_tr_b16 v[140:141], v251 offset:9728
    v_mfma_f32_16x16x32_bf16 v[4:7], v[128:131], v[164:167], v[4:7]
    ds_read_b64_tr_b16 v[142:143], v251 offset:13824
    v_mfma_f32_16x16x32_bf16 v[8:11], v[128:131], v[168:171], v[8:11]
    v_mfma_f32_16x16x32_bf16 v[12:15], v[128:131], v[172:175], v[12:15]
    s_waitcnt lgkmcnt(4)
    v_mfma_f32_16x16x32_bf16 v[16:19], v[132:135], v[160:163], v[16:19]
    ds_read_b64_tr_b16 v[144:145], v251 offset:10240
    v_mfma_f32_16x16x32_bf16 v[20:23], v[132:135], v[164:167], v[20:23]
    ds_read_b64_tr_b16 v[146:147], v251 offset:14336
    v_mfma_f32_16x16x32_bf16 v[24:27], v[132:135], v[168:171], v[24:27]
    v_mfma_f32_16x16x32_bf16 v[28:31], v[132:135], v[172:175], v[28:31]
    s_waitcnt lgkmcnt(4)
    v_mfma_f32_16x16x32_bf16 v[32:35], v[136:139], v[160:163], v[32:35]
    ds_read_b64_tr_b16 v[148:149], v251 offset:10752
    v_mfma_f32_16x16x32_bf16 v[36:39], v[136:139], v[164:167], v[36:39]
    ds_read_b64_tr_b16 v[150:151], v251 offset:14848
    v_mfma_f32_16x16x32_bf16 v[40:43], v[136:139], v[168:171], v[40:43]
    v_mfma_f32_16x16x32_bf16 v[44:47], v[136:139], v[172:175], v[44:47]
    s_waitcnt lgkmcnt(4)
    v_mfma_f32_16x16x32_bf16 v[48:51], v[140:143], v[160:163], v[48:51]
    ds_read_b64_tr_b16 v[152:153], v251 offset:11264
    v_mfma_f32_16x16x32_bf16 v[52:55], v[140:143], v[164:167], v[52:55]
    ds_read_b64_tr_b16 v[154:155], v251 offset:15360
    v_mfma_f32_16x16x32_bf16 v[56:59], v[140:143], v[168:171], v[56:59]
    v_mfma_f32_16x16x32_bf16 v[60:63], v[140:143], v[172:175], v[60:63]
    s_waitcnt lgkmcnt(4)
    v_mfma_f32_16x16x32_bf16 v[64:67], v[144:147], v[160:163], v[64:67]
    ds_read_b64_tr_b16 v[156:157], v251 offset:11776
    v_mfma_f32_16x16x32_bf16 v[68:71], v[144:147], v[164:167], v[68:71]
    ds_read_b64_tr_b16 v[158:159], v251 offset:15872
    v_mfma_f32_16x16x32_bf16 v[72:75], v[144:147], v[168:171], v[72:75]
    v_mfma_f32_16x16x32_bf16 v[76:79], v[144:147], v[172:175], v[76:79]
    s_waitcnt lgkmcnt(4)
    v_mfma_f32_16x16x32_bf16 v[80:83], v[148:151], v[160:163], v[80:83]
    v_mfma_f32_16x16x32_bf16 v[84:87], v[148:151], v[164:167], v[84:87]
    v_mfma_f32_16x16x32_bf16 v[88:91], v[148:151], v[168:171], v[88:91]
    v_mfma_f32_16x16x32_bf16 v[92:95], v[148:151], v[172:175], v[92:95]
    s_waitcnt lgkmcnt(2)
    v_mfma_f32_16x16x32_bf16 v[96:99], v[152:155], v[160:163], v[96:99]
    v_mfma_f32_16x16x32_bf16 v[100:103], v[152:155], v[164:167], v[100:103]
    v_mfma_f32_16x16x32_bf16 v[104:107], v[152:155], v[168:171], v[104:107]
    v_mfma_f32_16x16x32_bf16 v[108:111], v[152:155], v[172:175], v[108:111]
    s_waitcnt lgkmcnt(0)
    v_mfma_f32_16x16x32_bf16 v[112:115], v[156:159], v[160:163], v[112:115]
    v_mfma_f32_16x16x32_bf16 v[116:119], v[156:159], v[164:167], v[116:119]
    v_mfma_f32_16x16x32_bf16 v[120:123], v[156:159], v[168:171], v[120:123]
    v_mfma_f32_16x16x32_bf16 v[124:127], v[156:159], v[172:175], v[124:127]
    s_barrier
    s_mul_i32 s60, s24, 7168
    v_add_u32 v251, s60, v254
    v_mul_f32 v236, v5, v229
    v_mul_f32 v5, v5, v228
    v_pk_mul_f32 v[238:239], v[6:7], v[226:227]
    v_pk_mul_f32 v[6:7], v[6:7], v[224:225]
    v_fmac_f32_e64 v5, v1, v229
    v_fma_f32 v1, v1, v228, -v236
    v_pk_fma_f32 v[6:7], v[2:3], v[226:227], v[6:7]
    v_pk_fma_f32 v[2:3], v[2:3], v[224:225], v[238:239] neg_lo:[0,0,1] neg_hi:[0,0,1]
    v_pk_add_f32 v[236:237], v[0:1], v[2:3]
    v_pk_add_f32 v[238:239], v[0:1], v[2:3] neg_lo:[0,1] neg_hi:[0,1]
    v_pk_add_f32 v[240:241], v[4:5], v[6:7]
    v_pk_add_f32 v[242:243], v[4:5], v[6:7] neg_lo:[0,1] neg_hi:[0,1]
    v_pk_add_f32 v[0:1], v[236:237], v[236:237] op_sel:[0,1] op_sel_hi:[0,1] neg_hi:[0,1]
    v_pk_add_f32 v[4:5], v[240:241], v[240:241] op_sel:[0,1] op_sel_hi:[0,1] neg_hi:[1,0]
    v_pk_add_f32 v[2:3], v[238:239], v[242:243] op_sel:[0,1] op_sel_hi:[0,1] neg_lo:[0,1]
    v_pk_add_f32 v[6:7], v[242:243], v[238:239] op_sel:[0,1] op_sel_hi:[0,1] neg_hi:[1,0]
    v_mul_f32 v236, v21, v229
    v_mul_f32 v21, v21, v228
    v_pk_mul_f32 v[238:239], v[22:23], v[226:227]
    v_pk_mul_f32 v[22:23], v[22:23], v[224:225]
    v_fmac_f32_e64 v21, v17, v229
    v_fma_f32 v17, v17, v228, -v236
    v_pk_fma_f32 v[22:23], v[18:19], v[226:227], v[22:23]
    v_pk_fma_f32 v[18:19], v[18:19], v[224:225], v[238:239] neg_lo:[0,0,1] neg_hi:[0,0,1]
    v_pk_add_f32 v[236:237], v[16:17], v[18:19]
    v_pk_add_f32 v[238:239], v[16:17], v[18:19] neg_lo:[0,1] neg_hi:[0,1]
    v_pk_add_f32 v[240:241], v[20:21], v[22:23]
    v_pk_add_f32 v[242:243], v[20:21], v[22:23] neg_lo:[0,1] neg_hi:[0,1]
    v_pk_add_f32 v[16:17], v[236:237], v[236:237] op_sel:[0,1] op_sel_hi:[0,1] neg_hi:[0,1]
    v_pk_add_f32 v[20:21], v[240:241], v[240:241] op_sel:[0,1] op_sel_hi:[0,1] neg_hi:[1,0]
    v_pk_add_f32 v[18:19], v[238:239], v[242:243] op_sel:[0,1] op_sel_hi:[0,1] neg_lo:[0,1]
    v_pk_add_f32 v[22:23], v[242:243], v[238:239] op_sel:[0,1] op_sel_hi:[0,1] neg_hi:[1,0]
    v_mul_f32 v236, v37, v229
    v_mul_f32 v37, v37, v228
    v_pk_mul_f32 v[238:239], v[38:39], v[226:227]
    v_pk_mul_f32 v[38:39], v[38:39], v[224:225]
    v_fmac_f32_e64 v37, v33, v229
    v_fma_f32 v33, v33, v228, -v236
    v_pk_fma_f32 v[38:39], v[34:35], v[226:227], v[38:39]
    v_pk_fma_f32 v[34:35], v[34:35], v[224:225], v[238:239] neg_lo:[0,0,1] neg_hi:[0,0,1]
    v_pk_add_f32 v[236:237], v[32:33], v[34:35]
    v_pk_add_f32 v[238:239], v[32:33], v[34:35] neg_lo:[0,1] neg_hi:[0,1]
    v_pk_add_f32 v[240:241], v[36:37], v[38:39]
    v_pk_add_f32 v[242:243], v[36:37], v[38:39] neg_lo:[0,1] neg_hi:[0,1]
    v_pk_add_f32 v[32:33], v[236:237], v[236:237] op_sel:[0,1] op_sel_hi:[0,1] neg_hi:[0,1]
    v_pk_add_f32 v[36:37], v[240:241], v[240:241] op_sel:[0,1] op_sel_hi:[0,1] neg_hi:[1,0]
    v_pk_add_f32 v[34:35], v[238:239], v[242:243] op_sel:[0,1] op_sel_hi:[0,1] neg_lo:[0,1]
    v_pk_add_f32 v[38:39], v[242:243], v[238:239] op_sel:[0,1] op_sel_hi:[0,1] neg_hi:[1,0]
    v_mul_f32 v236, v53, v229
    v_mul_f32 v53, v53, v228
    v_pk_mul_f32 v[238:239], v[54:55], v[226:227]
    v_pk_mul_f32 v[54:55], v[54:55], v[224:225]
    v_fmac_f32_e64 v53, v49, v229
    v_fma_f32 v49, v49, v228, -v236
    v_pk_fma_f32 v[54:55], v[50:51], v[226:227], v[54:55]
    v_pk_fma_f32 v[50:51], v[50:51], v[224:225], v[238:239] neg_lo:[0,0,1] neg_hi:[0,0,1]
    v_pk_add_f32 v[236:237], v[48:49], v[50:51]
    v_pk_add_f32 v[238:239], v[48:49], v[50:51] neg_lo:[0,1] neg_hi:[0,1]
    v_pk_add_f32 v[240:241], v[52:53], v[54:55]
    v_pk_add_f32 v[242:243], v[52:53], v[54:55] neg_lo:[0,1] neg_hi:[0,1]
    v_pk_add_f32 v[48:49], v[236:237], v[236:237] op_sel:[0,1] op_sel_hi:[0,1] neg_hi:[0,1]
    v_pk_add_f32 v[52:53], v[240:241], v[240:241] op_sel:[0,1] op_sel_hi:[0,1] neg_hi:[1,0]
    v_pk_add_f32 v[50:51], v[238:239], v[242:243] op_sel:[0,1] op_sel_hi:[0,1] neg_lo:[0,1]
    v_pk_add_f32 v[54:55], v[242:243], v[238:239] op_sel:[0,1] op_sel_hi:[0,1] neg_hi:[1,0]
    v_mul_f32 v236, v69, v229
    v_mul_f32 v69, v69, v228
    v_pk_mul_f32 v[238:239], v[70:71], v[226:227]
    v_pk_mul_f32 v[70:71], v[70:71], v[224:225]
    v_fmac_f32_e64 v69, v65, v229
    v_fma_f32 v65, v65, v228, -v236
    v_pk_fma_f32 v[70:71], v[66:67], v[226:227], v[70:71]
    v_pk_fma_f32 v[66:67], v[66:67], v[224:225], v[238:239] neg_lo:[0,0,1] neg_hi:[0,0,1]
    v_pk_add_f32 v[236:237], v[64:65], v[66:67]
    v_pk_add_f32 v[238:239], v[64:65], v[66:67] neg_lo:[0,1] neg_hi:[0,1]
    v_pk_add_f32 v[240:241], v[68:69], v[70:71]
    v_pk_add_f32 v[242:243], v[68:69], v[70:71] neg_lo:[0,1] neg_hi:[0,1]
    v_pk_add_f32 v[64:65], v[236:237], v[236:237] op_sel:[0,1] op_sel_hi:[0,1] neg_hi:[0,1]
    v_pk_add_f32 v[68:69], v[240:241], v[240:241] op_sel:[0,1] op_sel_hi:[0,1] neg_hi:[1,0]
    v_pk_add_f32 v[66:67], v[238:239], v[242:243] op_sel:[0,1] op_sel_hi:[0,1] neg_lo:[0,1]
    v_pk_add_f32 v[70:71], v[242:243], v[238:239] op_sel:[0,1] op_sel_hi:[0,1] neg_hi:[1,0]
    v_mul_f32 v236, v85, v229
    v_mul_f32 v85, v85, v228
    v_pk_mul_f32 v[238:239], v[86:87], v[226:227]
    v_pk_mul_f32 v[86:87], v[86:87], v[224:225]
    v_fmac_f32_e64 v85, v81, v229
    v_fma_f32 v81, v81, v228, -v236
    v_pk_fma_f32 v[86:87], v[82:83], v[226:227], v[86:87]
    v_pk_fma_f32 v[82:83], v[82:83], v[224:225], v[238:239] neg_lo:[0,0,1] neg_hi:[0,0,1]
    v_pk_add_f32 v[236:237], v[80:81], v[82:83]
    v_pk_add_f32 v[238:239], v[80:81], v[82:83] neg_lo:[0,1] neg_hi:[0,1]
    v_pk_add_f32 v[240:241], v[84:85], v[86:87]
    v_pk_add_f32 v[242:243], v[84:85], v[86:87] neg_lo:[0,1] neg_hi:[0,1]
    v_pk_add_f32 v[80:81], v[236:237], v[236:237] op_sel:[0,1] op_sel_hi:[0,1] neg_hi:[0,1]
    v_pk_add_f32 v[84:85], v[240:241], v[240:241] op_sel:[0,1] op_sel_hi:[0,1] neg_hi:[1,0]
    v_pk_add_f32 v[82:83], v[238:239], v[242:243] op_sel:[0,1] op_sel_hi:[0,1] neg_lo:[0,1]
    v_pk_add_f32 v[86:87], v[242:243], v[238:239] op_sel:[0,1] op_sel_hi:[0,1] neg_hi:[1,0]
    v_mul_f32 v236, v101, v229
    v_mul_f32 v101, v101, v228
    v_pk_mul_f32 v[238:239], v[102:103], v[226:227]
    v_pk_mul_f32 v[102:103], v[102:103], v[224:225]
    v_fmac_f32_e64 v101, v97, v229
    v_fma_f32 v97, v97, v228, -v236
    v_pk_fma_f32 v[102:103], v[98:99], v[226:227], v[102:103]
    v_pk_fma_f32 v[98:99], v[98:99], v[224:225], v[238:239] neg_lo:[0,0,1] neg_hi:[0,0,1]
    v_pk_add_f32 v[236:237], v[96:97], v[98:99]
    v_pk_add_f32 v[238:239], v[96:97], v[98:99] neg_lo:[0,1] neg_hi:[0,1]
    v_pk_add_f32 v[240:241], v[100:101], v[102:103]
    v_pk_add_f32 v[242:243], v[100:101], v[102:103] neg_lo:[0,1] neg_hi:[0,1]
    v_pk_add_f32 v[96:97], v[236:237], v[236:237] op_sel:[0,1] op_sel_hi:[0,1] neg_hi:[0,1]
    v_pk_add_f32 v[100:101], v[240:241], v[240:241] op_sel:[0,1] op_sel_hi:[0,1] neg_hi:[1,0]
    v_pk_add_f32 v[98:99], v[238:239], v[242:243] op_sel:[0,1] op_sel_hi:[0,1] neg_lo:[0,1]
    v_pk_add_f32 v[102:103], v[242:243], v[238:239] op_sel:[0,1] op_sel_hi:[0,1] neg_hi:[1,0]
    v_mul_f32 v236, v117, v229
    v_mul_f32 v117, v117, v228
    v_pk_mul_f32 v[238:239], v[118:119], v[226:227]
    v_pk_mul_f32 v[118:119], v[118:119], v[224:225]
    v_fmac_f32_e64 v117, v113, v229
    v_fma_f32 v113, v113, v228, -v236
    v_pk_fma_f32 v[118:119], v[114:115], v[226:227], v[118:119]
    v_pk_fma_f32 v[114:115], v[114:115], v[224:225], v[238:239] neg_lo:[0,0,1] neg_hi:[0,0,1]
    v_pk_add_f32 v[236:237], v[112:113], v[114:115]
    v_pk_add_f32 v[238:239], v[112:113], v[114:115] neg_lo:[0,1] neg_hi:[0,1]
    v_pk_add_f32 v[240:241], v[116:117], v[118:119]
    v_pk_add_f32 v[242:243], v[116:117], v[118:119] neg_lo:[0,1] neg_hi:[0,1]
    v_pk_add_f32 v[112:113], v[236:237], v[236:237] op_sel:[0,1] op_sel_hi:[0,1] neg_hi:[0,1]
    v_pk_add_f32 v[116:117], v[240:241], v[240:241] op_sel:[0,1] op_sel_hi:[0,1] neg_hi:[1,0]
    v_pk_add_f32 v[114:115], v[238:239], v[242:243] op_sel:[0,1] op_sel_hi:[0,1] neg_lo:[0,1]
    v_pk_add_f32 v[118:119], v[242:243], v[238:239] op_sel:[0,1] op_sel_hi:[0,1] neg_hi:[1,0]
    v_cvt_pk_bf16_f32 v128, v0, v16
    v_cvt_pk_bf16_f32 v129, v32, v48
    v_cvt_pk_bf16_f32 v130, v64, v80
    v_cvt_pk_bf16_f32 v131, v96, v112
    v_cvt_pk_bf16_f32 v132, v1, v17
    v_cvt_pk_bf16_f32 v133, v33, v49
    v_cvt_pk_bf16_f32 v134, v65, v81
    v_cvt_pk_bf16_f32 v135, v97, v113
    v_cvt_pk_bf16_f32 v136, v2, v18
    v_cvt_pk_bf16_f32 v137, v34, v50
    v_cvt_pk_bf16_f32 v138, v66, v82
    v_cvt_pk_bf16_f32 v139, v98, v114
    v_cvt_pk_bf16_f32 v140, v3, v19
    v_cvt_pk_bf16_f32 v141, v35, v51
    v_cvt_pk_bf16_f32 v142, v67, v83
    v_cvt_pk_bf16_f32 v143, v99, v115
    v_cvt_pk_bf16_f32 v144, v4, v20
    v_cvt_pk_bf16_f32 v145, v36, v52
    v_cvt_pk_bf16_f32 v146, v68, v84
    v_cvt_pk_bf16_f32 v147, v100, v116
    v_cvt_pk_bf16_f32 v148, v5, v21
    v_cvt_pk_bf16_f32 v149, v37, v53
    v_cvt_pk_bf16_f32 v150, v69, v85
    v_cvt_pk_bf16_f32 v151, v101, v117
    v_cvt_pk_bf16_f32 v152, v6, v22
    v_cvt_pk_bf16_f32 v153, v38, v54
    v_cvt_pk_bf16_f32 v154, v70, v86
    v_cvt_pk_bf16_f32 v155, v102, v118
    v_cvt_pk_bf16_f32 v156, v7, v23
    v_cvt_pk_bf16_f32 v157, v39, v55
    v_cvt_pk_bf16_f32 v158, v71, v87
    v_cvt_pk_bf16_f32 v159, v103, v119
    v_mul_f32_e64 v236, v13, v235
    ds_write_b128 v254, v[128:131] offset:0
    v_mul_f32_e64 v13, v13, v234
    v_pk_mul_f32 v[238:239], v[14:15], v[232:233]
    v_pk_mul_f32 v[14:15], v[14:15], v[230:231]
    v_fmac_f32_e64 v13, v9, v235
    v_fma_f32 v9, v9, v234, -v236
    v_pk_fma_f32 v[14:15], v[10:11], v[232:233], v[14:15]
    v_pk_fma_f32 v[10:11], v[10:11], v[230:231], v[238:239] neg_lo:[0,0,1] neg_hi:[0,0,1]
    v_pk_add_f32 v[236:237], v[8:9], v[10:11]
    v_pk_add_f32 v[238:239], v[8:9], v[10:11] neg_lo:[0,1] neg_hi:[0,1]
    ds_write_b128 v254, v[132:135] offset:24576
    v_pk_add_f32 v[240:241], v[12:13], v[14:15]
    v_pk_add_f32 v[242:243], v[12:13], v[14:15] neg_lo:[0,1] neg_hi:[0,1]
    v_pk_add_f32 v[8:9], v[236:237], v[236:237] op_sel:[0,1] op_sel_hi:[0,1] neg_hi:[0,1]
    v_pk_add_f32 v[12:13], v[240:241], v[240:241] op_sel:[0,1] op_sel_hi:[0,1] neg_hi:[1,0]
    v_pk_add_f32 v[10:11], v[238:239], v[242:243] op_sel:[0,1] op_sel_hi:[0,1] neg_lo:[0,1]
    v_pk_add_f32 v[14:15], v[242:243], v[238:239] op_sel:[0,1] op_sel_hi:[0,1] neg_hi:[1,0]
    v_mul_f32 v236, v29, v235
    v_mul_f32 v29, v29, v234
    v_pk_mul_f32 v[238:239], v[30:31], v[232:233]
    ds_write_b128 v254, v[136:139] offset:16384
    v_pk_mul_f32 v[30:31], v[30:31], v[230:231]
    v_fmac_f32_e64 v29, v25, v235
    v_fma_f32 v25, v25, v234, -v236
    v_pk_fma_f32 v[30:31], v[26:27], v[232:233], v[30:31]
    v_pk_fma_f32 v[26:27], v[26:27], v[230:231], v[238:239] neg_lo:[0,0,1] neg_hi:[0,0,1]
    v_pk_add_f32 v[236:237], v[24:25], v[26:27]
    v_pk_add_f32 v[238:239], v[24:25], v[26:27] neg_lo:[0,1] neg_hi:[0,1]
    v_pk_add_f32 v[240:241], v[28:29], v[30:31]
    v_pk_add_f32 v[242:243], v[28:29], v[30:31] neg_lo:[0,1] neg_hi:[0,1]
    ds_write_b128 v254, v[140:143] offset:8192
    v_pk_add_f32 v[24:25], v[236:237], v[236:237] op_sel:[0,1] op_sel_hi:[0,1] neg_hi:[0,1]
    v_pk_add_f32 v[28:29], v[240:241], v[240:241] op_sel:[0,1] op_sel_hi:[0,1] neg_hi:[1,0]
    v_pk_add_f32 v[26:27], v[238:239], v[242:243] op_sel:[0,1] op_sel_hi:[0,1] neg_lo:[0,1]
    v_pk_add_f32 v[30:31], v[242:243], v[238:239] op_sel:[0,1] op_sel_hi:[0,1] neg_hi:[1,0]
    v_mul_f32 v236, v45, v235
    v_mul_f32 v45, v45, v234
    v_pk_mul_f32 v[238:239], v[46:47], v[232:233]
    v_pk_mul_f32 v[46:47], v[46:47], v[230:231]
    v_fmac_f32_e64 v45, v41, v235
    ds_write_b128 v254, v[144:147] offset:4096
    v_fma_f32 v41, v41, v234, -v236
    v_pk_fma_f32 v[46:47], v[42:43], v[232:233], v[46:47]
    v_pk_fma_f32 v[42:43], v[42:43], v[230:231], v[238:239] neg_lo:[0,0,1] neg_hi:[0,0,1]
    v_pk_add_f32 v[236:237], v[40:41], v[42:43]
    v_pk_add_f32 v[238:239], v[40:41], v[42:43] neg_lo:[0,1] neg_hi:[0,1]
    v_pk_add_f32 v[240:241], v[44:45], v[46:47]
    v_pk_add_f32 v[242:243], v[44:45], v[46:47] neg_lo:[0,1] neg_hi:[0,1]
    v_pk_add_f32 v[40:41], v[236:237], v[236:237] op_sel:[0,1] op_sel_hi:[0,1] neg_hi:[0,1]
    v_pk_add_f32 v[44:45], v[240:241], v[240:241] op_sel:[0,1] op_sel_hi:[0,1] neg_hi:[1,0]
    ds_write_b128 v254, v[148:151] offset:28672
    v_pk_add_f32 v[42:43], v[238:239], v[242:243] op_sel:[0,1] op_sel_hi:[0,1] neg_lo:[0,1]
    v_pk_add_f32 v[46:47], v[242:243], v[238:239] op_sel:[0,1] op_sel_hi:[0,1] neg_hi:[1,0]
    v_mul_f32 v236, v61, v235
    v_mul_f32 v61, v61, v234
    v_pk_mul_f32 v[238:239], v[62:63], v[232:233]
    v_pk_mul_f32 v[62:63], v[62:63], v[230:231]
    v_fmac_f32_e64 v61, v57, v235
    v_fma_f32 v57, v57, v234, -v236
    v_pk_fma_f32 v[62:63], v[58:59], v[232:233], v[62:63]
    ds_write_b128 v254, v[152:155] offset:20480
    v_pk_fma_f32 v[58:59], v[58:59], v[230:231], v[238:239] neg_lo:[0,0,1] neg_hi:[0,0,1]
    v_pk_add_f32 v[236:237], v[56:57], v[58:59]
    v_pk_add_f32 v[238:239], v[56:57], v[58:59] neg_lo:[0,1] neg_hi:[0,1]
    v_pk_add_f32 v[240:241], v[60:61], v[62:63]
    v_pk_add_f32 v[242:243], v[60:61], v[62:63] neg_lo:[0,1] neg_hi:[0,1]
    v_pk_add_f32 v[56:57], v[236:237], v[236:237] op_sel:[0,1] op_sel_hi:[0,1] neg_hi:[0,1]
    v_pk_add_f32 v[60:61], v[240:241], v[240:241] op_sel:[0,1] op_sel_hi:[0,1] neg_hi:[1,0]
    v_pk_add_f32 v[58:59], v[238:239], v[242:243] op_sel:[0,1] op_sel_hi:[0,1] neg_lo:[0,1]
    v_pk_add_f32 v[62:63], v[242:243], v[238:239] op_sel:[0,1] op_sel_hi:[0,1] neg_hi:[1,0]
    ds_write_b128 v254, v[156:159] offset:12288
    v_mul_f32 v236, v77, v235
    v_mul_f32 v77, v77, v234
    v_pk_mul_f32 v[238:239], v[78:79], v[232:233]
    v_pk_mul_f32 v[78:79], v[78:79], v[230:231]
    v_fmac_f32_e64 v77, v73, v235
    v_fma_f32 v73, v73, v234, -v236
    v_pk_fma_f32 v[78:79], v[74:75], v[232:233], v[78:79]
    v_pk_fma_f32 v[74:75], v[74:75], v[230:231], v[238:239] neg_lo:[0,0,1] neg_hi:[0,0,1]
    v_pk_add_f32 v[236:237], v[72:73], v[74:75]
    v_pk_add_f32 v[238:239], v[72:73], v[74:75] neg_lo:[0,1] neg_hi:[0,1]
    v_pk_add_f32 v[240:241], v[76:77], v[78:79]
    v_pk_add_f32 v[242:243], v[76:77], v[78:79] neg_lo:[0,1] neg_hi:[0,1]
    v_pk_add_f32 v[72:73], v[236:237], v[236:237] op_sel:[0,1] op_sel_hi:[0,1] neg_hi:[0,1]
    v_pk_add_f32 v[76:77], v[240:241], v[240:241] op_sel:[0,1] op_sel_hi:[0,1] neg_hi:[1,0]
    v_pk_add_f32 v[74:75], v[238:239], v[242:243] op_sel:[0,1] op_sel_hi:[0,1] neg_lo:[0,1]
    v_pk_add_f32 v[78:79], v[242:243], v[238:239] op_sel:[0,1] op_sel_hi:[0,1] neg_hi:[1,0]
    s_waitcnt lgkmcnt(0)
    s_barrier
    v_mul_f32_e64 v236, v93, v235
    ds_read_b128 v[128:131], v251 offset:0
    v_mul_f32_e64 v93, v93, v234
    v_pk_mul_f32 v[238:239], v[94:95], v[232:233]
    ds_read_b128 v[132:135], v251 offset:1024
    v_pk_mul_f32 v[94:95], v[94:95], v[230:231]
    v_fmac_f32_e64 v93, v89, v235
    ds_read_b128 v[136:139], v251 offset:4096
    v_fma_f32 v89, v89, v234, -v236
    v_pk_fma_f32 v[94:95], v[90:91], v[232:233], v[94:95]
    ds_read_b128 v[140:143], v251 offset:5120
    v_pk_fma_f32 v[90:91], v[90:91], v[230:231], v[238:239] neg_lo:[0,0,1] neg_hi:[0,0,1]
    v_pk_add_f32 v[236:237], v[88:89], v[90:91]
    ds_read_b128 v[144:147], v251 offset:2048
    v_pk_add_f32 v[238:239], v[88:89], v[90:91] neg_lo:[0,1] neg_hi:[0,1]
    v_pk_add_f32 v[240:241], v[92:93], v[94:95]
    ds_read_b128 v[148:151], v251 offset:3072
    v_pk_add_f32 v[242:243], v[92:93], v[94:95] neg_lo:[0,1] neg_hi:[0,1]
    v_pk_add_f32 v[88:89], v[236:237], v[236:237] op_sel:[0,1] op_sel_hi:[0,1] neg_hi:[0,1]
    ds_read_b128 v[152:155], v251 offset:6144
    v_pk_add_f32 v[92:93], v[240:241], v[240:241] op_sel:[0,1] op_sel_hi:[0,1] neg_hi:[1,0]
    v_pk_add_f32 v[90:91], v[238:239], v[242:243] op_sel:[0,1] op_sel_hi:[0,1] neg_lo:[0,1]
    ds_read_b128 v[156:159], v251 offset:7168
    v_pk_add_f32 v[94:95], v[242:243], v[238:239] op_sel:[0,1] op_sel_hi:[0,1] neg_hi:[1,0]
    v_mul_f32 v236, v109, v235
    v_mul_f32 v109, v109, v234
    v_pk_mul_f32 v[238:239], v[110:111], v[232:233]
    v_pk_mul_f32 v[110:111], v[110:111], v[230:231]
    v_fmac_f32_e64 v109, v105, v235
    v_fma_f32 v105, v105, v234, -v236
    v_pk_fma_f32 v[110:111], v[106:107], v[232:233], v[110:111]
    v_pk_fma_f32 v[106:107], v[106:107], v[230:231], v[238:239] neg_lo:[0,0,1] neg_hi:[0,0,1]
    v_pk_add_f32 v[236:237], v[104:105], v[106:107]
    v_pk_add_f32 v[238:239], v[104:105], v[106:107] neg_lo:[0,1] neg_hi:[0,1]
    v_pk_add_f32 v[240:241], v[108:109], v[110:111]
    v_pk_add_f32 v[242:243], v[108:109], v[110:111] neg_lo:[0,1] neg_hi:[0,1]
    v_pk_add_f32 v[104:105], v[236:237], v[236:237] op_sel:[0,1] op_sel_hi:[0,1] neg_hi:[0,1]
    v_pk_add_f32 v[108:109], v[240:241], v[240:241] op_sel:[0,1] op_sel_hi:[0,1] neg_hi:[1,0]
    v_pk_add_f32 v[106:107], v[238:239], v[242:243] op_sel:[0,1] op_sel_hi:[0,1] neg_lo:[0,1]
    v_pk_add_f32 v[110:111], v[242:243], v[238:239] op_sel:[0,1] op_sel_hi:[0,1] neg_hi:[1,0]
    v_mul_f32 v236, v125, v235
    v_mul_f32 v125, v125, v234
    v_pk_mul_f32 v[238:239], v[126:127], v[232:233]
    v_pk_mul_f32 v[126:127], v[126:127], v[230:231]
    v_fmac_f32_e64 v125, v121, v235
    v_fma_f32 v121, v121, v234, -v236
    v_pk_fma_f32 v[126:127], v[122:123], v[232:233], v[126:127]
    v_pk_fma_f32 v[122:123], v[122:123], v[230:231], v[238:239] neg_lo:[0,0,1] neg_hi:[0,0,1]
    v_pk_add_f32 v[236:237], v[120:121], v[122:123]
    v_pk_add_f32 v[238:239], v[120:121], v[122:123] neg_lo:[0,1] neg_hi:[0,1]
    v_pk_add_f32 v[240:241], v[124:125], v[126:127]
    v_pk_add_f32 v[242:243], v[124:125], v[126:127] neg_lo:[0,1] neg_hi:[0,1]
    v_pk_add_f32 v[120:121], v[236:237], v[236:237] op_sel:[0,1] op_sel_hi:[0,1] neg_hi:[0,1]
    v_pk_add_f32 v[124:125], v[240:241], v[240:241] op_sel:[0,1] op_sel_hi:[0,1] neg_hi:[1,0]
    v_pk_add_f32 v[122:123], v[238:239], v[242:243] op_sel:[0,1] op_sel_hi:[0,1] neg_lo:[0,1]
    v_pk_add_f32 v[126:127], v[242:243], v[238:239] op_sel:[0,1] op_sel_hi:[0,1] neg_hi:[1,0]
    s_waitcnt lgkmcnt(0)
    v_mfma_f32_16x16x32_bf16 v[0:3], v[192:195], v[128:131], 0
    v_cvt_pk_bf16_f32 v160, v8, v24
    v_cvt_pk_bf16_f32 v161, v40, v56
    v_mfma_f32_16x16x32_bf16 v[4:7], v[192:195], v[136:139], 0
    v_cvt_pk_bf16_f32 v162, v72, v88
    v_cvt_pk_bf16_f32 v163, v104, v120
    ds_write_b128 v254, v[160:163] offset:32768
    v_mfma_f32_16x16x32_bf16 v[16:19], v[192:195], v[144:147], 0
    v_cvt_pk_bf16_f32 v164, v9, v25
    v_cvt_pk_bf16_f32 v165, v41, v57
    v_mfma_f32_16x16x32_bf16 v[20:23], v[192:195], v[152:155], 0
    v_cvt_pk_bf16_f32 v166, v73, v89
    v_cvt_pk_bf16_f32 v167, v105, v121
    ds_write_b128 v254, v[164:167] offset:57344
    v_mfma_f32_16x16x32_bf16 v[0:3], v[196:199], v[132:135], v[0:3]
    v_cvt_pk_bf16_f32 v168, v10, v26
    v_cvt_pk_bf16_f32 v169, v42, v58
    v_mfma_f32_16x16x32_bf16 v[4:7], v[196:199], v[140:143], v[4:7]
    v_cvt_pk_bf16_f32 v170, v74, v90
    v_cvt_pk_bf16_f32 v171, v106, v122
    ds_write_b128 v254, v[168:171] offset:49152
    v_mfma_f32_16x16x32_bf16 v[16:19], v[196:199], v[148:151], v[16:19]
    v_cvt_pk_bf16_f32 v172, v11, v27
    v_cvt_pk_bf16_f32 v173, v43, v59
    v_mfma_f32_16x16x32_bf16 v[20:23], v[196:199], v[156:159], v[20:23]
    v_cvt_pk_bf16_f32 v174, v75, v91
    v_cvt_pk_bf16_f32 v175, v107, v123
    ds_write_b128 v254, v[172:175] offset:40960
    v_mfma_f32_16x16x32_bf16 v[32:35], v[200:203], v[128:131], 0
    v_cvt_pk_bf16_f32 v176, v12, v28
    v_cvt_pk_bf16_f32 v177, v44, v60
    v_mfma_f32_16x16x32_bf16 v[36:39], v[200:203], v[136:139], 0
    v_cvt_pk_bf16_f32 v178, v76, v92
    v_cvt_pk_bf16_f32 v179, v108, v124
    ds_write_b128 v254, v[176:179] offset:36864
    v_mfma_f32_16x16x32_bf16 v[48:51], v[200:203], v[144:147], 0
    v_cvt_pk_bf16_f32 v180, v13, v29
    v_cvt_pk_bf16_f32 v181, v45, v61
    v_mfma_f32_16x16x32_bf16 v[52:55], v[200:203], v[152:155], 0
    v_cvt_pk_bf16_f32 v182, v77, v93
    v_cvt_pk_bf16_f32 v183, v109, v125
    ds_write_b128 v254, v[180:183] offset:61440
    v_mfma_f32_16x16x32_bf16 v[32:35], v[204:207], v[132:135], v[32:35]
    v_cvt_pk_bf16_f32 v184, v14, v30
    v_cvt_pk_bf16_f32 v185, v46, v62
    v_mfma_f32_16x16x32_bf16 v[36:39], v[204:207], v[140:143], v[36:39]
    v_cvt_pk_bf16_f32 v186, v78, v94
    v_cvt_pk_bf16_f32 v187, v110, v126
    ds_write_b128 v254, v[184:187] offset:53248
    v_mfma_f32_16x16x32_bf16 v[48:51], v[204:207], v[148:151], v[48:51]
    v_cvt_pk_bf16_f32 v188, v15, v31
    v_cvt_pk_bf16_f32 v189, v47, v63
    v_mfma_f32_16x16x32_bf16 v[52:55], v[204:207], v[156:159], v[52:55]
    v_cvt_pk_bf16_f32 v190, v79, v95
    v_cvt_pk_bf16_f32 v191, v111, v127
    ds_write_b128 v254, v[188:191] offset:45056
    v_mfma_f32_16x16x32_bf16 v[64:67], v[208:211], v[128:131], 0
    v_cvt_pk_bf16_f32 v236, v0, v1
    v_cvt_pk_bf16_f32 v237, v4, v5
    v_mfma_f32_16x16x32_bf16 v[68:71], v[208:211], v[136:139], 0
    v_cvt_pk_bf16_f32 v238, v16, v17
    v_cvt_pk_bf16_f32 v239, v20, v21
    buffer_store_dwordx4 v[236:239], v252, s[20:23], s52 offen offset:0 sc1
    v_mfma_f32_16x16x32_bf16 v[80:83], v[208:211], v[144:147], 0
    v_cvt_pk_bf16_f32 v240, v2, v3
    v_cvt_pk_bf16_f32 v241, v6, v7
    v_mfma_f32_16x16x32_bf16 v[84:87], v[208:211], v[152:155], 0
    v_cvt_pk_bf16_f32 v242, v18, v19
    v_cvt_pk_bf16_f32 v243, v22, v23
    v_mfma_f32_16x16x32_bf16 v[96:99], v[216:219], v[128:131], 0
    buffer_store_dwordx4 v[240:243], v252, s[20:23], s53 offen offset:0 sc1
    v_cvt_pk_bf16_f32 v244, v32, v33
    v_mfma_f32_16x16x32_bf16 v[100:103], v[216:219], v[136:139], 0
    v_cvt_pk_bf16_f32 v245, v36, v37
    v_cvt_pk_bf16_f32 v246, v48, v49
    v_mfma_f32_16x16x32_bf16 v[112:115], v[216:219], v[144:147], 0
    v_cvt_pk_bf16_f32 v247, v52, v53
    buffer_store_dwordx4 v[244:247], v252, s[20:23], s54 offen offset:0 sc1
    v_mfma_f32_16x16x32_bf16 v[116:119], v[216:219], v[152:155], 0
    v_mfma_f32_16x16x32_bf16 v[64:67], v[212:215], v[132:135], v[64:67]
    v_mfma_f32_16x16x32_bf16 v[68:71], v[212:215], v[140:143], v[68:71]
    v_mfma_f32_16x16x32_bf16 v[80:83], v[212:215], v[148:151], v[80:83]
    v_mfma_f32_16x16x32_bf16 v[84:87], v[212:215], v[156:159], v[84:87]
    v_mfma_f32_16x16x32_bf16 v[96:99], v[220:223], v[132:135], v[96:99]
    v_mfma_f32_16x16x32_bf16 v[100:103], v[220:223], v[140:143], v[100:103]
    v_mfma_f32_16x16x32_bf16 v[112:115], v[220:223], v[148:151], v[112:115]
    v_mfma_f32_16x16x32_bf16 v[116:119], v[220:223], v[156:159], v[116:119]
    s_waitcnt lgkmcnt(0)
    s_barrier
    ds_read_b128 v[160:163], v251 offset:32768
    ds_read_b128 v[164:167], v251 offset:33792
    ds_read_b128 v[168:171], v251 offset:36864
    ds_read_b128 v[172:175], v251 offset:37888
    ds_read_b128 v[176:179], v251 offset:34816
    ds_read_b128 v[180:183], v251 offset:35840
    ds_read_b128 v[184:187], v251 offset:38912
    ds_read_b128 v[188:191], v251 offset:39936
    v_cvt_pk_bf16_f32 v236, v34, v35
    v_cvt_pk_bf16_f32 v237, v38, v39
    v_cvt_pk_bf16_f32 v238, v50, v51
    v_cvt_pk_bf16_f32 v239, v54, v55
    buffer_store_dwordx4 v[236:239], v252, s[20:23], s55 offen offset:0 sc1
    v_cvt_pk_bf16_f32 v240, v64, v65
    v_cvt_pk_bf16_f32 v241, v68, v69
    v_cvt_pk_bf16_f32 v242, v80, v81
    v_cvt_pk_bf16_f32 v243, v84, v85
    buffer_store_dwordx4 v[240:243], v252, s[20:23], s56 offen offset:0 sc1
    v_cvt_pk_bf16_f32 v244, v66, v67
    v_cvt_pk_bf16_f32 v245, v70, v71
    v_cvt_pk_bf16_f32 v246, v82, v83
    v_cvt_pk_bf16_f32 v247, v86, v87
    buffer_store_dwordx4 v[244:247], v252, s[20:23], s57 offen offset:0 sc1
    s_waitcnt lgkmcnt(0)
    v_mfma_f32_16x16x32_bf16 v[12:15], v[192:195], v[168:171], 0
    v_cvt_pk_bf16_f32 v238, v112, v113
    v_cvt_pk_bf16_f32 v239, v116, v117
    v_mfma_f32_16x16x32_bf16 v[8:11], v[192:195], v[160:163], 0
    v_cvt_pk_bf16_f32 v237, v100, v101
    v_cvt_pk_bf16_f32 v236, v96, v97
    buffer_store_dwordx4 v[236:239], v252, s[20:23], s58 offen offset:0 sc1
    v_mfma_f32_16x16x32_bf16 v[12:15], v[196:199], v[172:175], v[12:15]
    v_cvt_pk_bf16_f32 v243, v118, v119
    v_cvt_pk_bf16_f32 v241, v102, v103
    v_mfma_f32_16x16x32_bf16 v[28:31], v[192:195], v[184:187], 0
    v_cvt_pk_bf16_f32 v240, v98, v99
    v_cvt_pk_bf16_f32 v242, v114, v115
    v_mfma_f32_16x16x32_bf16 v[24:27], v[192:195], v[176:179], 0
    buffer_store_dwordx4 v[240:243], v252, s[20:23], s59 offen offset:0 sc1
    v_mfma_f32_16x16x32_bf16 v[24:27], v[196:199], v[180:183], v[24:27]
    v_cvt_pk_bf16_f32 v237, v12, v13
    v_cvt_pk_bf16_f32 v241, v14, v15
    v_mfma_f32_16x16x32_bf16 v[8:11], v[196:199], v[164:167], v[8:11]
    v_mfma_f32_16x16x32_bf16 v[28:31], v[196:199], v[188:191], v[28:31]
    v_mfma_f32_16x16x32_bf16 v[56:59], v[200:203], v[176:179], 0
    v_mfma_f32_16x16x32_bf16 v[56:59], v[204:207], v[180:183], v[56:59]
    v_mfma_f32_16x16x32_bf16 v[60:63], v[200:203], v[184:187], 0
    s_nop 0
    v_cvt_pk_bf16_f32 v238, v24, v25
    v_mfma_f32_16x16x32_bf16 v[40:43], v[200:203], v[160:163], 0
    v_cvt_pk_bf16_f32 v242, v26, v27
    v_cvt_pk_bf16_f32 v236, v8, v9
    v_mfma_f32_16x16x32_bf16 v[40:43], v[204:207], v[164:167], v[40:43]
    v_cvt_pk_bf16_f32 v239, v28, v29
    buffer_store_dwordx4 v[236:239], v253, s[20:23], s52 offen offset:256 sc1
    v_mfma_f32_16x16x32_bf16 v[44:47], v[200:203], v[168:171], 0
    v_cvt_pk_bf16_f32 v243, v30, v31
    v_cvt_pk_bf16_f32 v240, v10, v11
    v_mfma_f32_16x16x32_bf16 v[44:47], v[204:207], v[172:175], v[44:47]
    v_cvt_pk_bf16_f32 v246, v56, v57
    v_cvt_pk_bf16_f32 v238, v58, v59
    v_mfma_f32_16x16x32_bf16 v[60:63], v[204:207], v[188:191], v[60:63]
    buffer_store_dwordx4 v[240:243], v253, s[20:23], s53 offen offset:256 sc1
    v_cvt_pk_bf16_f32 v244, v40, v41
    v_mfma_f32_16x16x32_bf16 v[88:91], v[208:211], v[176:179], 0
    v_cvt_pk_bf16_f32 v236, v42, v43
    v_mfma_f32_16x16x32_bf16 v[88:91], v[212:215], v[180:183], v[88:91]
    v_cvt_pk_bf16_f32 v245, v44, v45
    v_cvt_pk_bf16_f32 v237, v46, v47
    v_mfma_f32_16x16x32_bf16 v[92:95], v[208:211], v[184:187], 0
    v_cvt_pk_bf16_f32 v247, v60, v61
    buffer_store_dwordx4 v[244:247], v253, s[20:23], s54 offen offset:256 sc1
    v_mfma_f32_16x16x32_bf16 v[76:79], v[208:211], v[168:171], 0
    v_cvt_pk_bf16_f32 v239, v62, v63
    v_mfma_f32_16x16x32_bf16 v[76:79], v[212:215], v[172:175], v[76:79]
    v_cvt_pk_bf16_f32 v242, v88, v89
    v_cvt_pk_bf16_f32 v246, v90, v91
    v_mfma_f32_16x16x32_bf16 v[72:75], v[208:211], v[160:163], 0
    buffer_store_dwordx4 v[236:239], v253, s[20:23], s55 offen offset:256 sc1
    v_mfma_f32_16x16x32_bf16 v[72:75], v[212:215], v[164:167], v[72:75]
    v_mfma_f32_16x16x32_bf16 v[92:95], v[212:215], v[188:191], v[92:95]
    v_mfma_f32_16x16x32_bf16 v[120:123], v[216:219], v[176:179], 0
    s_nop 0
    v_cvt_pk_bf16_f32 v241, v76, v77
    v_mfma_f32_16x16x32_bf16 v[108:111], v[216:219], v[168:171], 0
    v_cvt_pk_bf16_f32 v245, v78, v79
    v_mfma_f32_16x16x32_bf16 v[108:111], v[220:223], v[172:175], v[108:111]
    s_nop 0
    v_cvt_pk_bf16_f32 v240, v72, v73
    v_mfma_f32_16x16x32_bf16 v[104:107], v[216:219], v[160:163], 0
    v_cvt_pk_bf16_f32 v243, v92, v93
    buffer_store_dwordx4 v[240:243], v253, s[20:23], s56 offen offset:256 sc1
    v_mfma_f32_16x16x32_bf16 v[120:123], v[220:223], v[180:183], v[120:123]
    v_cvt_pk_bf16_f32 v244, v74, v75
    v_cvt_pk_bf16_f32 v247, v94, v95
    v_mfma_f32_16x16x32_bf16 v[124:127], v[216:219], v[184:187], 0
    v_cvt_pk_bf16_f32 v237, v108, v109
    v_cvt_pk_bf16_f32 v241, v110, v111
    v_mfma_f32_16x16x32_bf16 v[124:127], v[220:223], v[188:191], v[124:127]
    buffer_store_dwordx4 v[244:247], v253, s[20:23], s57 offen offset:256 sc1
    v_mfma_f32_16x16x32_bf16 v[104:107], v[220:223], v[164:167], v[104:107]
    v_cvt_pk_bf16_f32 v238, v120, v121
    v_cvt_pk_bf16_f32 v242, v122, v123
    s_nop 3
    v_cvt_pk_bf16_f32 v239, v124, v125
    v_cvt_pk_bf16_f32 v243, v126, v127
    v_cvt_pk_bf16_f32 v236, v104, v105
    buffer_store_dwordx4 v[236:239], v253, s[20:23], s58 offen offset:256 sc1
    v_cvt_pk_bf16_f32 v240, v106, v107
    buffer_store_dwordx4 v[240:243], v253, s[20:23], s59 offen offset:256 sc1

    s_barrier
    s_nop 0
    s_call_b64 s[70:71], S_cinit
    s_waitcnt vmcnt(0)
    s_barrier
    s_branch L_p2
L_pl:
    s_cmp_ge_u32 s26, 30
    s_cbranch_scc1 L_help
    s_cmp_lg_u32 s24, 7
    s_cbranch_scc1 L_l114
    s_mul_i32 s63, s25, 10
    s_add_u32 s63, s63, s52
    s_mulk_i32 s63, 6144
    s_add_u32 s63, s63, 983040
    v_lshlrev_b32 v19, 7, v0
    s_mov_b32 exec_hi, 0xffff
    buffer_load_dword v15, v19, s[16:19], s63 offen
    s_add_u32 s63, s63, 491520
    buffer_load_dword v15, v19, s[16:19], s63 offen
    s_add_u32 s63, s63, 491520
    buffer_load_dword v15, v19, s[16:19], s63 offen
    s_add_u32 s63, s63, 491520
    s_mov_b32 exec_hi, -1
L_l114:
L_p0:
    s_sub_u32 s53, s26, 26
    s_mul_i32 s54, s24, 4
    s_add_u32 s53, s53, s54
    s_mov_b32 s19, 0x20000
    s_waitcnt lgkmcnt(0)
    s_cmp_ge_u32 s53, 10
    s_cbranch_scc1 L_p1
    s_bfe_u32 s68, s25, 0x10001
    s_mulk_i32 s68, 1020
    s_mul_i32 s69, s53, 104
    s_add_u32 s68, s68, s69
    s_lshr_b32 s69, s25, 2
    s_add_u32 s68, s68, s69
    s_mulk_i32 s68, 1280
    s_add_u32 s68, s68, 384
    s_movk_i32 s69, 128
    v_mul_u32_u24 v16, 2560, v0
    s_movk_i32 s64, 52
    s_mov_b32 s18, 2621440
    s_mov_b64 s[16:17], s[4:5]
    s_branch L_p2a
L_p1:
    s_sub_u32 s68, s53, 10
    s_mulk_i32 s68, 54
    v_add_u32 v16, s68, v0
    v_mul_u32_u24 v17, 13108, v16
    v_lshrrev_b32 v17, 16, v17
    v_mul_u32_u24 v17, 5, v17
    v_add_lshl_u32 v16, v16, v17, 7
    s_and_b32 s68, s25, 1
    s_mulk_i32 s68, 640
    s_add_u32 s68, s68, 737280
    s_mov_b32 s69, 245760
    s_cmp_ge_u32 s53, 28
    s_cselect_b32 s64, 0, 54
    s_mov_b32 s18, 2457600
    s_mov_b64 s[16:17], s[6:7]
L_p2a:
    v_cmp_gt_u32 vcc, s64, v0
    v_bfrev_b32 v17, 1
    s_nop 0
    v_cndmask_b32 v14, v17, v16, vcc
    s_barrier
    buffer_load_dword v15, v14, s[16:19], s68 offen
    s_add_u32 s68, s68, s69
    s_barrier
    buffer_load_dword v15, v14, s[16:19], s68 offen
    s_add_u32 s68, s68, s69
    s_barrier
    buffer_load_dword v15, v14, s[16:19], s68 offen
    s_add_u32 s68, s68, s69
    s_barrier
    buffer_load_dword v15, v14, s[16:19], s68 offen
    s_add_u32 s68, s68, s69
    s_barrier
    buffer_load_dword v15, v14, s[16:19], s68 offen
    s_add_u32 s68, s68, s69
    s_barrier
    buffer_load_dword v15, v14, s[16:19], s68 offen
    s_add_u32 s68, s68, s69
    s_barrier
    buffer_load_dword v15, v14, s[16:19], s68 offen
    s_add_u32 s68, s68, s69
    s_waitcnt vmcnt(0)
    s_cmp_lt_u32 s24, 4
    s_cbranch_scc1 L_hc
    s_cmp_lg_u32 s24, 7
    s_cbranch_scc1 L_h2
    s_branch L_h6
L_hc0:
    s_cmp_lt_u32 s26, 30
    s_cbranch_scc1 L_p0
L_help:
    s_and_b32 s55, s26, 1
    s_lshl1_add_u32 s55, s25, s55
    s_lshl3_add_u32 s52, s55, s24
    s_waitcnt lgkmcnt(0)
    s_mov_b64 s[36:37], s[8:9]
    s_mov_b32 s38, 819200
    s_mov_b32 s39, 0x20000
    s_and_b32 s56, s55, 3
    s_mul_i32 s56, s56, 5
    s_add_u32 s56, s56, s24
    s_lshr_b32 s57, s55, 2
    s_mul_i32 s58, s56, 40960
    s_mul_i32 s59, s57, 320
    s_add_u32 s58, s58, s59
    s_mul_i32 s59, s24, 10240
    s_mov_b32 m0, s59
    v_add_u32 v5, 0, v0
    v_mul_u32_u24 v6, 3277, v5
    v_lshrrev_b32 v6, 16, v6
    v_mul_u32_u24 v6, 960, v6
    v_lshl_add_u32 v10, v5, 4, v6
    v_add_u32 v5, 64, v0
    v_mul_u32_u24 v6, 3277, v5
    v_lshrrev_b32 v6, 16, v6
    v_mul_u32_u24 v6, 960, v6
    v_lshl_add_u32 v11, v5, 4, v6
    v_add_u32 v5, 128, v0
    v_mul_u32_u24 v6, 3277, v5
    v_lshrrev_b32 v6, 16, v6
    v_mul_u32_u24 v6, 960, v6
    v_lshl_add_u32 v12, v5, 4, v6
    v_add_u32 v5, 192, v0
    v_mul_u32_u24 v6, 3277, v5
    v_lshrrev_b32 v6, 16, v6
    v_mul_u32_u24 v6, 960, v6
    v_lshl_add_u32 v13, v5, 4, v6
    v_add_u32 v5, 256, v0
    v_mul_u32_u24 v6, 3277, v5
    v_lshrrev_b32 v6, 16, v6
    v_mul_u32_u24 v6, 960, v6
    v_lshl_add_u32 v14, v5, 4, v6
    s_barrier
    s_cmp_ge_u32 s24, 5
    s_cbranch_scc1 L_ha
    buffer_load_dwordx4 v10, s[36:39], s58 offen   lds
    s_addk_i32 m0, 1024
    s_nop 0
    buffer_load_dwordx4 v11, s[36:39], s58 offen   lds
    s_addk_i32 m0, 1024
    s_nop 0
    buffer_load_dwordx4 v12, s[36:39], s58 offen   lds
    s_addk_i32 m0, 1024
    s_nop 0
    buffer_load_dwordx4 v13, s[36:39], s58 offen   lds
    s_addk_i32 m0, 1024
    s_nop 0
    buffer_load_dwordx4 v14, s[36:39], s58 offen   lds
    s_addk_i32 m0, 1024
L_ha:
    s_mov_b64 s[12:13], s[50:51]
    s_mov_b32 s14, 2621440
    s_mov_b32 s15, 0x20000
    s_mov_b64 s[20:21], s[48:49]
    s_mov_b32 s22, 256
    s_mov_b32 s23, 0x20000
    s_sub_u32 s53, s52, s55
    s_mulk_i32 s53, 23552
    s_add_u32 s53, s53, 0
    v_lshlrev_b32 v8, 4, v0
    v_mov_b64 v[24:25], -1
    v_mov_b64 v[26:27], -1
    s_cmp_lg_u32 s24, 7
    s_cbranch_scc1 L_hz
    s_add_u32 s32, s50, 5570560
    s_addc_u32 s33, s51, 0
    s_mov_b32 s34, 40960
    s_mov_b32 s35, 0x20000
    v_mov_b64 v[4:5], 0
    v_mov_b64 v[6:7], 0
    v_lshlrev_b32 v9, 7, v0
    s_lshl_b32 s54, s55, 13
    buffer_store_dwordx4 v[4:7], v9, s[32:35], s54 offen sc1
    buffer_atomic_add v6, v9, s[20:23], 0 offen sc1
L_hz:
    s_cmp_ge_u32 s24, 5
    s_cbranch_scc1 L_hb
    s_add_u32 s58, s58, 20480
    buffer_load_dwordx4 v10, s[36:39], s58 offen   lds
    s_addk_i32 m0, 1024
    s_nop 0
    buffer_load_dwordx4 v11, s[36:39], s58 offen   lds
    s_addk_i32 m0, 1024
    s_nop 0
    buffer_load_dwordx4 v12, s[36:39], s58 offen   lds
    s_addk_i32 m0, 1024
    s_nop 0
    buffer_load_dwordx4 v13, s[36:39], s58 offen   lds
    s_addk_i32 m0, 1024
    s_nop 0
    buffer_load_dwordx4 v14, s[36:39], s58 offen   lds
    s_addk_i32 m0, 1024
L_hb:
    s_cmp_ge_u32 s24, 5
    s_cbranch_scc1 L_h1
    v_bfe_u32 v5, v0, 2, 2
    v_lshrrev_b32 v2, 4, v0
    v_lshl_add_u32 v5, v2, 3, v5
    v_mul_u32_u24 v5, 320, v5
    v_and_b32 v6, 3, v0
    v_lshl_add_u32 v5, v6, 3, v5
    v_add_u32 v5, s59, v5
    s_mul_i32 s57, s57, 204800
    s_lshl_b32 s58, s56, 11
    s_add_u32 s58, s58, s57
    s_mul_i32 s59, s56, 3072
    s_add_u32 s59, s59, s57
    s_add_u32 s59, s59, 40960
    s_add_u32 s36, s50, 6422528
    s_addc_u32 s37, s51, 0
    s_mov_b32 s38, 819200
    s_mov_b32 s39, 0x20000
    s_waitcnt vmcnt(0)
    ds_read_b64_tr_b16 v[144:145], v5 offset:0
    ds_read_b64_tr_b16 v[146:147], v5 offset:1280
    ds_read_b64_tr_b16 v[148:149], v5 offset:32
    ds_read_b64_tr_b16 v[150:151], v5 offset:1312
    ds_read_b64_tr_b16 v[152:153], v5 offset:64
    ds_read_b64_tr_b16 v[154:155], v5 offset:1344
    ds_read_b64_tr_b16 v[156:157], v5 offset:96
    ds_read_b64_tr_b16 v[158:159], v5 offset:1376
    ds_read_b64_tr_b16 v[160:161], v5 offset:128
    ds_read_b64_tr_b16 v[162:163], v5 offset:1408
    s_waitcnt lgkmcnt(0)
    buffer_store_dwordx4 v[144:147], v8, s[36:39], s58 offen offset:0 sc1
    buffer_store_dwordx4 v[148:151], v8, s[36:39], s58 offen offset:1024 sc1
    buffer_store_dwordx4 v[152:155], v8, s[36:39], s59 offen offset:0 sc1
    buffer_store_dwordx4 v[156:159], v8, s[36:39], s59 offen offset:1024 sc1
    buffer_store_dwordx4 v[160:163], v8, s[36:39], s59 offen offset:2048 sc1
    s_add_u32 s58, s58, 102400
    s_add_u32 s59, s59, 102400
    ds_read_b64_tr_b16 v[164:165], v5 offset:160
    ds_read_b64_tr_b16 v[166:167], v5 offset:1440
    ds_read_b64_tr_b16 v[168:169], v5 offset:192
    ds_read_b64_tr_b16 v[170:171], v5 offset:1472
    ds_read_b64_tr_b16 v[172:173], v5 offset:224
    ds_read_b64_tr_b16 v[174:175], v5 offset:1504
    ds_read_b64_tr_b16 v[176:177], v5 offset:256
    ds_read_b64_tr_b16 v[178:179], v5 offset:1536
    ds_read_b64_tr_b16 v[180:181], v5 offset:288
    ds_read_b64_tr_b16 v[182:183], v5 offset:1568
    s_waitcnt lgkmcnt(0)
    buffer_store_dwordx4 v[164:167], v8, s[36:39], s58 offen offset:0 sc1
    buffer_store_dwordx4 v[168:171], v8, s[36:39], s58 offen offset:1024 sc1
    buffer_store_dwordx4 v[172:175], v8, s[36:39], s59 offen offset:0 sc1
    buffer_store_dwordx4 v[176:179], v8, s[36:39], s59 offen offset:1024 sc1
    buffer_store_dwordx4 v[180:183], v8, s[36:39], s59 offen offset:2048 sc1
    s_add_u32 s58, s58, 102400
    s_add_u32 s59, s59, 102400
L_h1:
    s_waitcnt vmcnt(0)
    s_barrier
    s_cmp_lg_u32 s24, 7
    s_cbranch_scc1 L_h4
    s_mov_b32 s54, 1
    s_atomic_add s54, s[48:49], 0 glc
    s_waitcnt lgkmcnt(0)
    s_cmp_lg_u32 s54, 15
    s_cbranch_scc1 L_h5
    s_mov_b32 s54, 1
    s_atomic_add s54, s[48:49], 128 glc
L_h5:
    s_mov_b64 s[36:37], s[48:49]
    s_mov_b32 s38, 256
    s_mov_b32 s39, 0x20000
    v_mov_b32 v4, 0
    s_mov_b64 exec, 1
    s_mov_b32 s74, 200000
L_hl15:
    buffer_load_dword v5, v4, s[36:39], 0 offen offset:128 sc1
    s_sub_u32 s74, s74, 1
    s_cbranch_scc1 L_hc16
    s_waitcnt vmcnt(0)
    v_cmp_ne_u32 vcc, 1, v5
    s_cbranch_vccz L_hc16
    s_branch L_hl15
L_hc16:
    s_mov_b64 exec, -1
    s_branch L_h7
L_h4:
    buffer_store_dwordx4 v[24:27], v8, s[12:15], s53 offen offset:0 sc1
    buffer_store_dwordx4 v[24:27], v8, s[12:15], s53 offen offset:1024 sc1
    buffer_store_dwordx4 v[24:27], v8, s[12:15], s53 offen offset:2048 sc1
    buffer_store_dwordx4 v[24:27], v8, s[12:15], s53 offen offset:3072 sc1
    s_addk_i32 s53, 4096
    buffer_store_dwordx4 v[24:27], v8, s[12:15], s53 offen offset:0 sc1
    buffer_store_dwordx4 v[24:27], v8, s[12:15], s53 offen offset:1024 sc1
    buffer_store_dwordx4 v[24:27], v8, s[12:15], s53 offen offset:2048 sc1
    buffer_store_dwordx4 v[24:27], v8, s[12:15], s53 offen offset:3072 sc1
    s_addk_i32 s53, 4096
    buffer_store_dwordx4 v[24:27], v8, s[12:15], s53 offen offset:0 sc1
    buffer_store_dwordx4 v[24:27], v8, s[12:15], s53 offen offset:1024 sc1
    buffer_store_dwordx4 v[24:27], v8, s[12:15], s53 offen offset:2048 sc1
    buffer_store_dwordx4 v[24:27], v8, s[12:15], s53 offen offset:3072 sc1
    s_addk_i32 s53, 4096
    buffer_store_dwordx4 v[24:27], v8, s[12:15], s53 offen offset:0 sc1
    buffer_store_dwordx4 v[24:27], v8, s[12:15], s53 offen offset:1024 sc1
    buffer_store_dwordx4 v[24:27], v8, s[12:15], s53 offen offset:2048 sc1
    buffer_store_dwordx4 v[24:27], v8, s[12:15], s53 offen offset:3072 sc1
    s_addk_i32 s53, 4096
    buffer_store_dwordx4 v[24:27], v8, s[12:15], s53 offen offset:0 sc1
    buffer_store_dwordx4 v[24:27], v8, s[12:15], s53 offen offset:1024 sc1
    buffer_store_dwordx4 v[24:27], v8, s[12:15], s53 offen offset:2048 sc1
    buffer_store_dwordx4 v[24:27], v8, s[12:15], s53 offen offset:3072 sc1
    s_addk_i32 s53, 4096
    buffer_store_dwordx4 v[24:27], v8, s[12:15], s53 offen offset:0 sc1
    buffer_store_dwordx4 v[24:27], v8, s[12:15], s53 offen offset:1024 sc1
    buffer_store_dwordx4 v[24:27], v8, s[12:15], s53 offen offset:2048 sc1
L_h7:
    s_waitcnt vmcnt(0)
    s_barrier
    s_cmp_lt_u32 s24, 4
    s_cbranch_scc1 L_hc
    s_cmp_lg_u32 s24, 7
    s_cbranch_scc1 L_h2
    s_add_u32 s32, s50, 5570560
    s_addc_u32 s33, s51, 0
    s_mov_b32 s34, 40960
    s_mov_b32 s35, 0x20000
    v_mov_b32 v6, 1
    v_mov_b32 v7, 1
    v_lshlrev_b32 v9, 7, v0
    s_movk_i32 s63, 8200
    s_waitcnt lgkmcnt(0)
    s_mov_b32 s54, 1
    s_atomic_add s54, s[32:33], 1280 glc
    s_waitcnt lgkmcnt(0)
    s_cmp_lg_u32 s54, 15
    s_cbranch_scc1 L_h2
    buffer_store_dword v7, v9, s[32:35], s63 offen sc1
    s_addk_i32 s63, 8192
    buffer_store_dword v7, v9, s[32:35], s63 offen sc1
    s_branch L_h2
L_h6:
    s_mov_b64 s[36:37], s[48:49]
    s_mov_b32 s38, 256
    s_mov_b32 s39, 0x20000
    v_mov_b32 v4, 0
    s_mov_b64 exec, 1
    s_mov_b32 s74, 200000
L_hl17:
    buffer_load_dword v5, v4, s[36:39], 0 offen offset:128 sc1
    s_sub_u32 s74, s74, 1
    s_cbranch_scc1 L_hc18
    s_waitcnt vmcnt(0)
    v_cmp_ne_u32 vcc, 1, v5
    s_cbranch_vccz L_hc18
    s_branch L_hl17
L_hc18:
    s_mov_b64 exec, -1
L_h2:
    s_call_b64 s[70:71], S_ldsetup
    s_barrier
    s_mov_b32 m0, 61440
    s_mov_b32 s66, 0
    s_call_b64 s[70:71], S_woround
    s_mov_b32 m0, 81920
    s_mov_b32 s66, 20480
    s_call_b64 s[70:71], S_woround
    s_mov_b32 m0, 0
    s_mov_b32 s66, 40960
    s_call_b64 s[70:71], S_woround
    s_mov_b32 m0, 20480
    s_mov_b32 s66, 61440
    s_call_b64 s[70:71], S_woround
    s_mov_b32 m0, 40960
    s_mov_b32 s66, 81920
    s_call_b64 s[70:71], S_woround
    s_call_b64 s[70:71], S_voff0
    s_call_b64 s[70:71], S_voff1
    s_call_b64 s[70:71], S_voff2
    s_call_b64 s[70:71], S_voff3
    s_call_b64 s[70:71], S_voff4
    s_call_b64 s[70:71], S_voff5
    s_waitcnt vmcnt(0)
    s_branch L_nqw2
L_hc:
    s_call_b64 s[70:71], S_cinit
    s_barrier
    s_branch L_p2
.p2align 12
.fill 394, 4, 0xbf800000
L_qc:
    s_bfe_u32 s55, s25, 0x10001
    s_mulk_i32 s55, 20
    s_add_u32 s55, s55, s26
    s_and_b32 s53, s55, 3
    v_and_b32 v1, 15, v0
    v_lshrrev_b32 v2, 4, v0
    v_lshrrev_b32 v3, 1, v1
    v_xor_b32 v3, v3, v2
    v_lshlrev_b32 v3, 4, v3
    v_lshl_add_u32 v3, v1, 7, v3
    v_add_u32 v224, 73728, v3
    v_xor_b32 v225, 64, v224
    v_lshrrev_b32 v3, 2, v0
    v_mul_u32_u24 v3, 160, v3
    s_mul_i32 s60, s24, 40
    v_add_u32 v3, s60, v3
    v_and_b32 v4, 3, v0
    v_lshl_add_u32 v226, v4, 3, v3
    v_add_u32 v3, 32, v3
    v_cmp_eq_u32 vcc, 1, v4
    v_cmp_eq_u32 s[60:61], 2, v4
    v_cmp_eq_u32 s[62:63], 3, v4
    v_add_u32 v5, 10240, v3
    v_add_u32 v6, 5120, v3
    v_mov_b32 v7, 0x40000
    v_cndmask_b32 v228, v3, v5, vcc
    v_cndmask_b32 v240, 0, 1.0, vcc
    v_cndmask_b32 v228, v228, v6, s[60:61]
    v_cndmask_b32 v228, v228, v7, s[62:63]
    s_mul_i32 s63, s24, 5
    s_lshl2_add_u32 s62, s53, s63
    v_add_u32 v4, s62, v4
    v_cmp_le_u32 vcc, 16, v4
    v_mov_b32 v8, 2560
    s_cmp_ge_u32 s62, 12
    s_cselect_b32 s62, 2560, 0
    v_cndmask_b32 v4, 0, v8, vcc
    v_sub_u32 v8, v8, v4
    v_add_u32 v227, v226, v8
    v_add_u32 v226, v226, v4
    s_sub_u32 s61, 2560, s62
    v_add_u32 v229, s61, v228
    v_add_u32 v228, s62, v228
    v_mov_b32 v241, v240
    v_mov_b32 v242, v240
    v_mov_b32 v243, v240
    v_mul_u32_u24 v3, 176, v1
    v_add_u32 v3, 144128, v3
    v_add_u32 v4, s63, v2
    v_lshl_add_u32 v230, v4, 3, v3
    s_add_u32 s63, s63, 4
    s_lshl_b32 s63, s63, 3
    v_lshl_add_u32 v3, v2, 1, v3
    v_add_u32 v231, s63, v3
    v_lshlrev_b32 v3, 2, v2
    v_sub_u32 v3, v1, v3
    v_mov_b32 v5, 0xff800000
    v_mov_b32 v6, 0xffff
    v_mov_b32 v7, 0xffff0000
    v_subrev_u32 v4, 0, v3
    v_cmp_gt_u32 vcc, 8, v4
    v_cmp_gt_i32 s[60:61], -8, v4
    v_cmp_le_i32 s[62:63], 0, v4
    v_cndmask_b32 v232, v5, 0, vcc
    v_cndmask_b32 v236, v5, 0, s[60:61]
    v_cndmask_b32 v244, 0, v6, s[62:63]
    v_subrev_u32 v4, 1, v3
    v_cmp_gt_u32 vcc, 8, v4
    v_cmp_gt_i32 s[60:61], -8, v4
    v_cmp_le_i32 s[62:63], 0, v4
    v_cndmask_b32 v233, v5, 0, vcc
    v_cndmask_b32 v237, v5, 0, s[60:61]
    v_cndmask_b32 v8, 0, v7, s[62:63]
    v_or_b32 v244, v244, v8
    v_subrev_u32 v4, 2, v3
    v_cmp_gt_u32 vcc, 8, v4
    v_cmp_gt_i32 s[60:61], -8, v4
    v_cmp_le_i32 s[62:63], 0, v4
    v_cndmask_b32 v234, v5, 0, vcc
    v_cndmask_b32 v238, v5, 0, s[60:61]
    v_cndmask_b32 v245, 0, v6, s[62:63]
    v_subrev_u32 v4, 3, v3
    v_cmp_gt_u32 vcc, 8, v4
    v_cmp_gt_i32 s[60:61], -8, v4
    v_cmp_le_i32 s[62:63], 0, v4
    v_cndmask_b32 v235, v5, 0, vcc
    v_cndmask_b32 v239, v5, 0, s[60:61]
    v_cndmask_b32 v8, 0, v7, s[62:63]
    v_or_b32 v245, v245, v8
    v_mov_b32 v246, 0
    v_mov_b32 v247, 0
    s_mov_b32 s60, 0x3f80
    s_mov_b32 s61, 0x3f800000
    v_writelane_b32 v246, s60, 16
    v_writelane_b32 v246, s61, 20
    v_writelane_b32 v247, s60, 24
    v_writelane_b32 v247, s61, 28
    s_mov_b32 s60, 0x3ea52b5c
    s_mov_b32 s61, s60
    s_waitcnt lgkmcnt(0)
.p2align 3
    s_nop 0
    s_barrier
    ds_read_b64_tr_b16 v[140:141], v226 offset:0
    ds_read_b64_tr_b16 v[142:143], v227 offset:0
    ds_read_b64_tr_b16 v[144:145], v226 offset:5120
    ds_read_b64_tr_b16 v[146:147], v227 offset:5120
    ds_read_b64_tr_b16 v[148:149], v226 offset:10240
    ds_read_b64_tr_b16 v[150:151], v227 offset:10240
    ds_read_b64_tr_b16 v[152:153], v228 offset:0
    ds_read_b64_tr_b16 v[154:155], v229 offset:0
    ds_read_b128 v[112:115], v224 offset:28672
    ds_read_b128 v[116:119], v224 offset:30720
    ds_read_b128 v[120:123], v224 offset:32768
    ds_read_b128 v[124:127], v224 offset:34816
    ds_read_b128 v[128:131], v224 offset:36864
    ds_read_b128 v[132:135], v224 offset:38912
    ds_read_b128 v[136:139], v224 offset:40960
.p2align 3
    s_waitcnt lgkmcnt(0)
    s_barrier
    v_mfma_f32_16x16x32_bf16 v[0:3], v[140:143], v[112:115], 0
    ds_read_b64_tr_b16 v[184:185], v226 offset:15360
    v_mfma_f32_16x16x32_bf16 v[4:7], v[144:147], v[112:115], 0
    ds_read_b64_tr_b16 v[186:187], v227 offset:15360
    v_mfma_f32_16x16x32_bf16 v[12:15], v[152:155], v[112:115], 0
    ds_read_b64_tr_b16 v[188:189], v226 offset:20480
    v_mfma_f32_16x16x32_bf16 v[28:31], v[152:155], v[116:119], 0
    ds_read_b64_tr_b16 v[190:191], v227 offset:20480
    v_mfma_f32_16x16x32_bf16 v[20:23], v[144:147], v[116:119], 0
    ds_read_b64_tr_b16 v[192:193], v226 offset:25600
    v_mfma_f32_16x16x32_bf16 v[16:19], v[140:143], v[116:119], 0
    ds_read_b64_tr_b16 v[194:195], v227 offset:25600
    v_mfma_f32_16x16x32_bf16 v[32:35], v[140:143], v[120:123], 0
    ds_read_b64_tr_b16 v[196:197], v228 offset:15360
    v_mfma_f32_16x16x32_bf16 v[36:39], v[144:147], v[120:123], 0
    ds_read_b64_tr_b16 v[198:199], v229 offset:15360
    v_mfma_f32_16x16x32_bf16 v[44:47], v[152:155], v[120:123], 0
    ds_read_b128 v[156:159], v225 offset:28672
    v_mfma_f32_16x16x32_bf16 v[60:63], v[152:155], v[124:127], 0
    ds_read_b128 v[160:163], v225 offset:30720
    v_mfma_f32_16x16x32_bf16 v[52:55], v[144:147], v[124:127], 0
    ds_read_b128 v[164:167], v225 offset:32768
    v_mfma_f32_16x16x32_bf16 v[48:51], v[140:143], v[124:127], 0
    ds_read_b128 v[168:171], v225 offset:34816
    v_mfma_f32_16x16x32_bf16 v[64:67], v[140:143], v[128:131], 0
    ds_read_b128 v[172:175], v225 offset:36864
    v_mfma_f32_16x16x32_bf16 v[68:71], v[144:147], v[128:131], 0
    ds_read_b128 v[176:179], v225 offset:38912
    v_mfma_f32_16x16x32_bf16 v[76:79], v[152:155], v[128:131], 0
    ds_read_b128 v[180:183], v225 offset:40960
    v_mfma_f32_16x16x32_bf16 v[92:95], v[152:155], v[132:135], 0
    v_mfma_f32_16x16x32_bf16 v[84:87], v[144:147], v[132:135], 0
    v_mfma_f32_16x16x32_bf16 v[80:83], v[140:143], v[132:135], 0
    v_mfma_f32_16x16x32_bf16 v[96:99], v[140:143], v[136:139], 0
    v_mfma_f32_16x16x32_bf16 v[100:103], v[144:147], v[136:139], 0
    v_mfma_f32_16x16x32_bf16 v[108:111], v[152:155], v[136:139], 0
    v_mfma_f32_16x16x32_bf16 v[8:11], v[112:115], v[148:151], 0
    v_mfma_f32_16x16x32_bf16 v[24:27], v[116:119], v[148:151], 0
    v_mfma_f32_16x16x32_bf16 v[40:43], v[120:123], v[148:151], 0
    v_mfma_f32_16x16x32_bf16 v[56:59], v[124:127], v[148:151], 0
    v_mfma_f32_16x16x32_bf16 v[72:75], v[128:131], v[148:151], 0
    v_mfma_f32_16x16x32_bf16 v[88:91], v[132:135], v[148:151], 0
    v_mfma_f32_16x16x32_bf16 v[104:107], v[136:139], v[148:151], 0
.p2align 3
    s_waitcnt lgkmcnt(0)
    s_barrier
    v_mfma_f32_16x16x32_bf16 v[0:3], v[184:187], v[156:159], v[0:3]
    ds_read_b64_tr_b16 v[140:141], v226 offset:30720
    v_mfma_f32_16x16x32_bf16 v[4:7], v[188:191], v[156:159], v[4:7]
    ds_read_b64_tr_b16 v[142:143], v227 offset:30720
    v_mfma_f32_16x16x32_bf16 v[12:15], v[196:199], v[156:159], v[12:15]
    ds_read_b64_tr_b16 v[144:145], v226 offset:35840
    v_mfma_f32_16x16x32_bf16 v[28:31], v[196:199], v[160:163], v[28:31]
    ds_read_b64_tr_b16 v[146:147], v227 offset:35840
    v_mfma_f32_16x16x32_bf16 v[20:23], v[188:191], v[160:163], v[20:23]
    ds_read_b64_tr_b16 v[148:149], v226 offset:40960
    v_mfma_f32_16x16x32_bf16 v[16:19], v[184:187], v[160:163], v[16:19]
    ds_read_b64_tr_b16 v[150:151], v227 offset:40960
    v_mfma_f32_16x16x32_bf16 v[32:35], v[184:187], v[164:167], v[32:35]
    ds_read_b64_tr_b16 v[152:153], v228 offset:30720
    v_mfma_f32_16x16x32_bf16 v[36:39], v[188:191], v[164:167], v[36:39]
    ds_read_b64_tr_b16 v[154:155], v229 offset:30720
    v_mfma_f32_16x16x32_bf16 v[44:47], v[196:199], v[164:167], v[44:47]
    ds_read_b128 v[112:115], v224 offset:0
    v_mfma_f32_16x16x32_bf16 v[60:63], v[196:199], v[168:171], v[60:63]
    ds_read_b128 v[116:119], v224 offset:2048
    v_mfma_f32_16x16x32_bf16 v[52:55], v[188:191], v[168:171], v[52:55]
    ds_read_b128 v[120:123], v224 offset:4096
    v_mfma_f32_16x16x32_bf16 v[48:51], v[184:187], v[168:171], v[48:51]
    ds_read_b128 v[124:127], v224 offset:6144
    v_mfma_f32_16x16x32_bf16 v[64:67], v[184:187], v[172:175], v[64:67]
    ds_read_b128 v[128:131], v224 offset:8192
    v_mfma_f32_16x16x32_bf16 v[68:71], v[188:191], v[172:175], v[68:71]
    ds_read_b128 v[132:135], v224 offset:10240
    v_mfma_f32_16x16x32_bf16 v[76:79], v[196:199], v[172:175], v[76:79]
    ds_read_b128 v[136:139], v224 offset:12288
    v_mfma_f32_16x16x32_bf16 v[92:95], v[196:199], v[176:179], v[92:95]
    s_and_b32 s27, s26, 7
    v_mfma_f32_16x16x32_bf16 v[84:87], v[188:191], v[176:179], v[84:87]
    s_lshr_b32 s72, s26, 3
    v_mfma_f32_16x16x32_bf16 v[80:83], v[184:187], v[176:179], v[80:83]
    s_and_b32 s28, s25, 3
    v_mfma_f32_16x16x32_bf16 v[96:99], v[184:187], v[180:183], v[96:99]
    s_lshl2_add_u32 s28, s28, s72
    v_mfma_f32_16x16x32_bf16 v[100:103], v[188:191], v[180:183], v[100:103]
    s_lshr_b32 s73, s25, 2
    v_mfma_f32_16x16x32_bf16 v[108:111], v[196:199], v[180:183], v[108:111]
    s_lshl1_add_u32 s28, s28, s73
    v_mfma_f32_16x16x32_bf16 v[8:11], v[156:159], v[192:195], v[8:11]
    v_mfma_f32_16x16x32_bf16 v[24:27], v[160:163], v[192:195], v[24:27]
    v_mfma_f32_16x16x32_bf16 v[40:43], v[164:167], v[192:195], v[40:43]
    v_mfma_f32_16x16x32_bf16 v[56:59], v[168:171], v[192:195], v[56:59]
    v_mfma_f32_16x16x32_bf16 v[72:75], v[172:175], v[192:195], v[72:75]
    v_mfma_f32_16x16x32_bf16 v[88:91], v[176:179], v[192:195], v[88:91]
    v_mfma_f32_16x16x32_bf16 v[104:107], v[180:183], v[192:195], v[104:107]
.p2align 3
    s_waitcnt lgkmcnt(0)
    s_barrier
    v_mfma_f32_16x16x32_bf16 v[0:3], v[140:143], v[112:115], v[0:3]
    ds_read_b64_tr_b16 v[184:185], v226 offset:46080
    v_mfma_f32_16x16x32_bf16 v[4:7], v[144:147], v[112:115], v[4:7]
    ds_read_b64_tr_b16 v[186:187], v227 offset:46080
    v_mfma_f32_16x16x32_bf16 v[12:15], v[152:155], v[112:115], v[12:15]
    ds_read_b64_tr_b16 v[188:189], v226 offset:51200
    v_mfma_f32_16x16x32_bf16 v[28:31], v[152:155], v[116:119], v[28:31]
    ds_read_b64_tr_b16 v[190:191], v227 offset:51200
    v_mfma_f32_16x16x32_bf16 v[20:23], v[144:147], v[116:119], v[20:23]
    ds_read_b64_tr_b16 v[192:193], v226 offset:56320
    v_mfma_f32_16x16x32_bf16 v[16:19], v[140:143], v[116:119], v[16:19]
    ds_read_b64_tr_b16 v[194:195], v227 offset:56320
    v_mfma_f32_16x16x32_bf16 v[32:35], v[140:143], v[120:123], v[32:35]
    ds_read_b64_tr_b16 v[196:197], v228 offset:46080
    v_mfma_f32_16x16x32_bf16 v[36:39], v[144:147], v[120:123], v[36:39]
    ds_read_b64_tr_b16 v[198:199], v229 offset:46080
    v_mfma_f32_16x16x32_bf16 v[44:47], v[152:155], v[120:123], v[44:47]
    ds_read_b128 v[156:159], v225 offset:0
    v_mfma_f32_16x16x32_bf16 v[60:63], v[152:155], v[124:127], v[60:63]
    ds_read_b128 v[160:163], v225 offset:2048
    v_mfma_f32_16x16x32_bf16 v[52:55], v[144:147], v[124:127], v[52:55]
    ds_read_b128 v[164:167], v225 offset:4096
    v_mfma_f32_16x16x32_bf16 v[48:51], v[140:143], v[124:127], v[48:51]
    ds_read_b128 v[168:171], v225 offset:6144
    v_mfma_f32_16x16x32_bf16 v[64:67], v[140:143], v[128:131], v[64:67]
    ds_read_b128 v[172:175], v225 offset:8192
    v_mfma_f32_16x16x32_bf16 v[68:71], v[144:147], v[128:131], v[68:71]
    ds_read_b128 v[176:179], v225 offset:10240
    v_mfma_f32_16x16x32_bf16 v[76:79], v[152:155], v[128:131], v[76:79]
    ds_read_b128 v[180:183], v225 offset:12288
    v_mfma_f32_16x16x32_bf16 v[92:95], v[152:155], v[132:135], v[92:95]
    s_sub_u32 s29, 64, s28
    v_mfma_f32_16x16x32_bf16 v[84:87], v[144:147], v[132:135], v[84:87]
    s_cmp_eq_u32 s28, 0
    v_mfma_f32_16x16x32_bf16 v[80:83], v[140:143], v[132:135], v[80:83]
    s_cselect_b32 s29, 32, s29
    v_mfma_f32_16x16x32_bf16 v[96:99], v[140:143], v[136:139], v[96:99]
    s_and_b32 s73, s24, 3
    v_mfma_f32_16x16x32_bf16 v[100:103], v[144:147], v[136:139], v[100:103]
    s_cmp_lt_u32 s73, 2
    v_mfma_f32_16x16x32_bf16 v[108:111], v[152:155], v[136:139], v[108:111]
    s_cselect_b32 s98, s28, s29
    v_mfma_f32_16x16x32_bf16 v[8:11], v[112:115], v[148:151], v[8:11]
    v_mfma_f32_16x16x32_bf16 v[24:27], v[116:119], v[148:151], v[24:27]
    v_mfma_f32_16x16x32_bf16 v[40:43], v[120:123], v[148:151], v[40:43]
    v_mfma_f32_16x16x32_bf16 v[56:59], v[124:127], v[148:151], v[56:59]
    v_mfma_f32_16x16x32_bf16 v[72:75], v[128:131], v[148:151], v[72:75]
    v_mfma_f32_16x16x32_bf16 v[88:91], v[132:135], v[148:151], v[88:91]
    v_mfma_f32_16x16x32_bf16 v[104:107], v[136:139], v[148:151], v[104:107]
.p2align 3
    s_waitcnt lgkmcnt(0)
    s_barrier
    v_mfma_f32_16x16x32_bf16 v[0:3], v[184:187], v[156:159], v[0:3]
    ds_read_b64_tr_b16 v[140:141], v226 offset:0
    v_mfma_f32_16x16x32_bf16 v[4:7], v[188:191], v[156:159], v[4:7]
    ds_read_b64_tr_b16 v[142:143], v227 offset:0
    v_mfma_f32_16x16x32_bf16 v[12:15], v[196:199], v[156:159], v[12:15]
    ds_read_b64_tr_b16 v[144:145], v226 offset:5120
    v_mfma_f32_16x16x32_bf16 v[28:31], v[196:199], v[160:163], v[28:31]
    ds_read_b64_tr_b16 v[146:147], v227 offset:5120
    v_mfma_f32_16x16x32_bf16 v[20:23], v[188:191], v[160:163], v[20:23]
    ds_read_b64_tr_b16 v[148:149], v226 offset:10240
    v_mfma_f32_16x16x32_bf16 v[16:19], v[184:187], v[160:163], v[16:19]
    ds_read_b64_tr_b16 v[150:151], v227 offset:10240
    v_mfma_f32_16x16x32_bf16 v[32:35], v[184:187], v[164:167], v[32:35]
    ds_read_b64_tr_b16 v[152:153], v228 offset:0
    v_mfma_f32_16x16x32_bf16 v[36:39], v[188:191], v[164:167], v[36:39]
    ds_read_b64_tr_b16 v[154:155], v229 offset:0
    v_mfma_f32_16x16x32_bf16 v[44:47], v[196:199], v[164:167], v[44:47]
    ds_read_b128 v[112:115], v224 offset:14336
    v_mfma_f32_16x16x32_bf16 v[60:63], v[196:199], v[168:171], v[60:63]
    ds_read_b128 v[116:119], v224 offset:16384
    v_mfma_f32_16x16x32_bf16 v[52:55], v[188:191], v[168:171], v[52:55]
    ds_read_b128 v[120:123], v224 offset:18432
    v_mfma_f32_16x16x32_bf16 v[48:51], v[184:187], v[168:171], v[48:51]
    ds_read_b128 v[124:127], v224 offset:20480
    v_mfma_f32_16x16x32_bf16 v[64:67], v[184:187], v[172:175], v[64:67]
    ds_read_b128 v[128:131], v224 offset:22528
    v_mfma_f32_16x16x32_bf16 v[68:71], v[188:191], v[172:175], v[68:71]
    ds_read_b128 v[132:135], v224 offset:24576
    v_mfma_f32_16x16x32_bf16 v[76:79], v[196:199], v[172:175], v[76:79]
    ds_read_b128 v[136:139], v224 offset:26624
    v_mfma_f32_16x16x32_bf16 v[92:95], v[196:199], v[176:179], v[92:95]
    s_and_b32 s72, s73, 1
    v_mfma_f32_16x16x32_bf16 v[84:87], v[188:191], v[176:179], v[84:87]
    s_lshl_b32 s72, s72, 10
    v_mfma_f32_16x16x32_bf16 v[80:83], v[184:187], v[176:179], v[80:83]
    s_add_u32 s98, s98, s72
    v_mfma_f32_16x16x32_bf16 v[96:99], v[184:187], v[180:183], v[96:99]
    s_mul_i32 s99, s73, 10240
    v_mfma_f32_16x16x32_bf16 v[100:103], v[188:191], v[180:183], v[100:103]
    s_add_u32 s99, s99, 102400
    v_mfma_f32_16x16x32_bf16 v[108:111], v[196:199], v[180:183], v[108:111]
    s_lshl_b32 s42, s24, 6
    v_mfma_f32_16x16x32_bf16 v[8:11], v[156:159], v[192:195], v[8:11]
    v_mfma_f32_16x16x32_bf16 v[24:27], v[160:163], v[192:195], v[24:27]
    v_mfma_f32_16x16x32_bf16 v[40:43], v[164:167], v[192:195], v[40:43]
    v_mfma_f32_16x16x32_bf16 v[56:59], v[168:171], v[192:195], v[56:59]
    v_mfma_f32_16x16x32_bf16 v[72:75], v[172:175], v[192:195], v[72:75]
    v_mfma_f32_16x16x32_bf16 v[88:91], v[176:179], v[192:195], v[88:91]
    v_mfma_f32_16x16x32_bf16 v[104:107], v[180:183], v[192:195], v[104:107]
.p2align 3
    s_waitcnt lgkmcnt(0)
    s_barrier
    v_mfma_f32_16x16x32_bf16 v[0:3], v[140:143], v[112:115], v[0:3]
    ds_read_b64_tr_b16 v[184:185], v226 offset:15360
    v_mfma_f32_16x16x32_bf16 v[4:7], v[144:147], v[112:115], v[4:7]
    ds_read_b64_tr_b16 v[186:187], v227 offset:15360
    v_mfma_f32_16x16x32_bf16 v[12:15], v[152:155], v[112:115], v[12:15]
    ds_read_b64_tr_b16 v[188:189], v226 offset:20480
    v_mfma_f32_16x16x32_bf16 v[28:31], v[152:155], v[116:119], v[28:31]
    ds_read_b64_tr_b16 v[190:191], v227 offset:20480
    v_mfma_f32_16x16x32_bf16 v[20:23], v[144:147], v[116:119], v[20:23]
    ds_read_b64_tr_b16 v[192:193], v226 offset:25600
    v_mfma_f32_16x16x32_bf16 v[16:19], v[140:143], v[116:119], v[16:19]
    ds_read_b64_tr_b16 v[194:195], v227 offset:25600
    v_mfma_f32_16x16x32_bf16 v[32:35], v[140:143], v[120:123], v[32:35]
    ds_read_b64_tr_b16 v[196:197], v228 offset:15360
    v_mfma_f32_16x16x32_bf16 v[36:39], v[144:147], v[120:123], v[36:39]
    ds_read_b64_tr_b16 v[198:199], v229 offset:15360
    v_mfma_f32_16x16x32_bf16 v[44:47], v[152:155], v[120:123], v[44:47]
    ds_read_b128 v[156:159], v225 offset:14336
    v_mfma_f32_16x16x32_bf16 v[60:63], v[152:155], v[124:127], v[60:63]
    ds_read_b128 v[160:163], v225 offset:16384
    v_mfma_f32_16x16x32_bf16 v[52:55], v[144:147], v[124:127], v[52:55]
    ds_read_b128 v[164:167], v225 offset:18432
    v_mfma_f32_16x16x32_bf16 v[48:51], v[140:143], v[124:127], v[48:51]
    ds_read_b128 v[168:171], v225 offset:20480
    v_mfma_f32_16x16x32_bf16 v[64:67], v[140:143], v[128:131], v[64:67]
    ds_read_b128 v[172:175], v225 offset:22528
    v_mfma_f32_16x16x32_bf16 v[68:71], v[144:147], v[128:131], v[68:71]
    ds_read_b128 v[176:179], v225 offset:24576
    v_mfma_f32_16x16x32_bf16 v[76:79], v[152:155], v[128:131], v[76:79]
    ds_read_b128 v[180:183], v225 offset:26624
    v_mfma_f32_16x16x32_bf16 v[92:95], v[152:155], v[132:135], v[92:95]
    s_add_u32 s42, s42, 105472
    v_mfma_f32_16x16x32_bf16 v[84:87], v[144:147], v[132:135], v[84:87]
    s_mul_i32 s41, s98, 1280
    v_mfma_f32_16x16x32_bf16 v[80:83], v[140:143], v[132:135], v[80:83]
    s_mul_i32 s72, s27, 160
    v_mfma_f32_16x16x32_bf16 v[96:99], v[140:143], v[136:139], v[96:99]
    s_add_u32 s41, s41, s72
    v_mfma_f32_16x16x32_bf16 v[100:103], v[144:147], v[136:139], v[100:103]
    s_cmp_lt_u32 s27, 4
    v_mfma_f32_16x16x32_bf16 v[108:111], v[152:155], v[136:139], v[108:111]
    s_cselect_b32 s67, -1.0, 1.0
    v_mfma_f32_16x16x32_bf16 v[8:11], v[112:115], v[148:151], v[8:11]
    v_mfma_f32_16x16x32_bf16 v[24:27], v[116:119], v[148:151], v[24:27]
    v_mfma_f32_16x16x32_bf16 v[40:43], v[120:123], v[148:151], v[40:43]
    v_mfma_f32_16x16x32_bf16 v[56:59], v[124:127], v[148:151], v[56:59]
    v_mfma_f32_16x16x32_bf16 v[72:75], v[128:131], v[148:151], v[72:75]
    v_mfma_f32_16x16x32_bf16 v[88:91], v[132:135], v[148:151], v[88:91]
    v_mfma_f32_16x16x32_bf16 v[104:107], v[136:139], v[148:151], v[104:107]
.p2align 3
    s_waitcnt lgkmcnt(0)
    s_barrier
    v_mfma_f32_16x16x32_bf16 v[0:3], v[184:187], v[156:159], v[0:3]
    ds_read_b64_tr_b16 v[140:141], v226 offset:30720
    v_mfma_f32_16x16x32_bf16 v[4:7], v[188:191], v[156:159], v[4:7]
    ds_read_b64_tr_b16 v[142:143], v227 offset:30720
    v_mfma_f32_16x16x32_bf16 v[12:15], v[196:199], v[156:159], v[12:15]
    ds_read_b64_tr_b16 v[144:145], v226 offset:35840
    v_mfma_f32_16x16x32_bf16 v[28:31], v[196:199], v[160:163], v[28:31]
    ds_read_b64_tr_b16 v[146:147], v227 offset:35840
    v_mfma_f32_16x16x32_bf16 v[20:23], v[188:191], v[160:163], v[20:23]
    ds_read_b64_tr_b16 v[148:149], v226 offset:40960
    v_mfma_f32_16x16x32_bf16 v[16:19], v[184:187], v[160:163], v[16:19]
    ds_read_b64_tr_b16 v[150:151], v227 offset:40960
    v_mfma_f32_16x16x32_bf16 v[32:35], v[184:187], v[164:167], v[32:35]
    ds_read_b64_tr_b16 v[152:153], v228 offset:30720
    v_mfma_f32_16x16x32_bf16 v[36:39], v[188:191], v[164:167], v[36:39]
    ds_read_b64_tr_b16 v[154:155], v229 offset:30720
    v_mfma_f32_16x16x32_bf16 v[44:47], v[196:199], v[164:167], v[44:47]
    ds_read_b128 v[112:115], v224 offset:28672
    v_mfma_f32_16x16x32_bf16 v[60:63], v[196:199], v[168:171], v[60:63]
    ds_read_b128 v[116:119], v224 offset:30720
    v_mfma_f32_16x16x32_bf16 v[52:55], v[188:191], v[168:171], v[52:55]
    ds_read_b128 v[120:123], v224 offset:32768
    v_mfma_f32_16x16x32_bf16 v[48:51], v[184:187], v[168:171], v[48:51]
    ds_read_b128 v[124:127], v224 offset:34816
    v_mfma_f32_16x16x32_bf16 v[64:67], v[184:187], v[172:175], v[64:67]
    ds_read_b128 v[128:131], v224 offset:36864
    v_mfma_f32_16x16x32_bf16 v[68:71], v[188:191], v[172:175], v[68:71]
    ds_read_b128 v[132:135], v224 offset:38912
    v_mfma_f32_16x16x32_bf16 v[76:79], v[196:199], v[172:175], v[76:79]
    ds_read_b128 v[136:139], v224 offset:40960
    v_mfma_f32_16x16x32_bf16 v[92:95], v[196:199], v[176:179], v[92:95]
    s_cmp_lt_u32 s24, 2
    v_mfma_f32_16x16x32_bf16 v[84:87], v[188:191], v[176:179], v[84:87]
    s_cselect_b32 s65, -1.0, 1.0
    v_mfma_f32_16x16x32_bf16 v[80:83], v[184:187], v[176:179], v[80:83]
    s_cselect_b32 s72, 0, 0x80000000
    v_mfma_f32_16x16x32_bf16 v[96:99], v[184:187], v[180:183], v[96:99]
    s_cselect_b32 s73, 0, 1
    v_mfma_f32_16x16x32_bf16 v[100:103], v[188:191], v[180:183], v[100:103]
    s_xor_b32 s68, s67, s72
    v_mfma_f32_16x16x32_bf16 v[108:111], v[196:199], v[180:183], v[108:111]
    s_cmp_eq_u32 s28, 0
    v_mfma_f32_16x16x32_bf16 v[8:11], v[156:159], v[192:195], v[8:11]
    v_mfma_f32_16x16x32_bf16 v[24:27], v[160:163], v[192:195], v[24:27]
    v_mfma_f32_16x16x32_bf16 v[40:43], v[164:167], v[192:195], v[40:43]
    v_mfma_f32_16x16x32_bf16 v[56:59], v[168:171], v[192:195], v[56:59]
    v_mfma_f32_16x16x32_bf16 v[72:75], v[172:175], v[192:195], v[72:75]
    v_mfma_f32_16x16x32_bf16 v[88:91], v[176:179], v[192:195], v[88:91]
    v_mfma_f32_16x16x32_bf16 v[104:107], v[180:183], v[192:195], v[104:107]
.p2align 3
    s_waitcnt lgkmcnt(0)
    s_barrier
    v_mfma_f32_16x16x32_bf16 v[0:3], v[140:143], v[112:115], v[0:3]
    ds_read_b64_tr_b16 v[184:185], v226 offset:46080
    v_mfma_f32_16x16x32_bf16 v[4:7], v[144:147], v[112:115], v[4:7]
    ds_read_b64_tr_b16 v[186:187], v227 offset:46080
    v_mfma_f32_16x16x32_bf16 v[12:15], v[152:155], v[112:115], v[12:15]
    ds_read_b64_tr_b16 v[188:189], v226 offset:51200
    v_mfma_f32_16x16x32_bf16 v[28:31], v[152:155], v[116:119], v[28:31]
    ds_read_b64_tr_b16 v[190:191], v227 offset:51200
    v_mfma_f32_16x16x32_bf16 v[20:23], v[144:147], v[116:119], v[20:23]
    ds_read_b64_tr_b16 v[192:193], v226 offset:56320
    v_mfma_f32_16x16x32_bf16 v[16:19], v[140:143], v[116:119], v[16:19]
    ds_read_b64_tr_b16 v[194:195], v227 offset:56320
    v_mfma_f32_16x16x32_bf16 v[32:35], v[140:143], v[120:123], v[32:35]
    ds_read_b64_tr_b16 v[196:197], v228 offset:46080
    v_mfma_f32_16x16x32_bf16 v[36:39], v[144:147], v[120:123], v[36:39]
    ds_read_b64_tr_b16 v[198:199], v229 offset:46080
    v_mfma_f32_16x16x32_bf16 v[44:47], v[152:155], v[120:123], v[44:47]
    ds_read_b128 v[156:159], v225 offset:28672
    v_mfma_f32_16x16x32_bf16 v[60:63], v[152:155], v[124:127], v[60:63]
    ds_read_b128 v[160:163], v225 offset:30720
    v_mfma_f32_16x16x32_bf16 v[52:55], v[144:147], v[124:127], v[52:55]
    ds_read_b128 v[164:167], v225 offset:32768
    v_mfma_f32_16x16x32_bf16 v[48:51], v[140:143], v[124:127], v[48:51]
    ds_read_b128 v[168:171], v225 offset:34816
    v_mfma_f32_16x16x32_bf16 v[64:67], v[140:143], v[128:131], v[64:67]
    ds_read_b128 v[172:175], v225 offset:36864
    v_mfma_f32_16x16x32_bf16 v[68:71], v[144:147], v[128:131], v[68:71]
    ds_read_b128 v[176:179], v225 offset:38912
    v_mfma_f32_16x16x32_bf16 v[76:79], v[152:155], v[128:131], v[76:79]
    ds_read_b128 v[180:183], v225 offset:40960
    v_mfma_f32_16x16x32_bf16 v[92:95], v[152:155], v[132:135], v[92:95]
    s_cselect_b32 s65, 0, s65
    v_mfma_f32_16x16x32_bf16 v[84:87], v[144:147], v[132:135], v[84:87]
    s_cselect_b32 s68, 0, s68
    v_mfma_f32_16x16x32_bf16 v[80:83], v[140:143], v[132:135], v[80:83]
    s_cselect_b32 s73, s73, 0
    v_mfma_f32_16x16x32_bf16 v[96:99], v[140:143], v[136:139], v[96:99]
    s_cmp_eq_u32 s73, 1
    v_mfma_f32_16x16x32_bf16 v[100:103], v[144:147], v[136:139], v[100:103]
    s_cselect_b32 s64, 0, 1.0
    v_mfma_f32_16x16x32_bf16 v[108:111], v[152:155], v[136:139], v[108:111]
    s_cselect_b32 s66, 1.0, 0
    v_mfma_f32_16x16x32_bf16 v[8:11], v[112:115], v[148:151], v[8:11]
    v_mfma_f32_16x16x32_bf16 v[24:27], v[116:119], v[148:151], v[24:27]
    v_mfma_f32_16x16x32_bf16 v[40:43], v[120:123], v[148:151], v[40:43]
    v_mfma_f32_16x16x32_bf16 v[56:59], v[124:127], v[148:151], v[56:59]
    v_mfma_f32_16x16x32_bf16 v[72:75], v[128:131], v[148:151], v[72:75]
    v_mfma_f32_16x16x32_bf16 v[88:91], v[132:135], v[148:151], v[88:91]
    v_mfma_f32_16x16x32_bf16 v[104:107], v[136:139], v[148:151], v[104:107]
.p2align 3
    s_waitcnt lgkmcnt(0)
    s_barrier
    v_mfma_f32_16x16x32_bf16 v[0:3], v[184:187], v[156:159], v[0:3]
    ds_read_b64_tr_b16 v[140:141], v226 offset:0
    v_mfma_f32_16x16x32_bf16 v[4:7], v[188:191], v[156:159], v[4:7]
    ds_read_b64_tr_b16 v[142:143], v227 offset:0
    v_mfma_f32_16x16x32_bf16 v[12:15], v[196:199], v[156:159], v[12:15]
    ds_read_b64_tr_b16 v[144:145], v226 offset:5120
    v_mfma_f32_16x16x32_bf16 v[28:31], v[196:199], v[160:163], v[28:31]
    ds_read_b64_tr_b16 v[146:147], v227 offset:5120
    v_mfma_f32_16x16x32_bf16 v[20:23], v[188:191], v[160:163], v[20:23]
    ds_read_b64_tr_b16 v[148:149], v226 offset:10240
    v_mfma_f32_16x16x32_bf16 v[16:19], v[184:187], v[160:163], v[16:19]
    ds_read_b64_tr_b16 v[150:151], v227 offset:10240
    v_mfma_f32_16x16x32_bf16 v[32:35], v[184:187], v[164:167], v[32:35]
    ds_read_b64_tr_b16 v[152:153], v228 offset:0
    v_mfma_f32_16x16x32_bf16 v[36:39], v[188:191], v[164:167], v[36:39]
    ds_read_b64_tr_b16 v[154:155], v229 offset:0
    v_mfma_f32_16x16x32_bf16 v[44:47], v[196:199], v[164:167], v[44:47]
    ds_read_b128 v[112:115], v224 offset:0
    v_mfma_f32_16x16x32_bf16 v[60:63], v[196:199], v[168:171], v[60:63]
    ds_read_b128 v[116:119], v224 offset:2048
    v_mfma_f32_16x16x32_bf16 v[52:55], v[188:191], v[168:171], v[52:55]
    ds_read_b128 v[120:123], v224 offset:4096
    v_mfma_f32_16x16x32_bf16 v[48:51], v[184:187], v[168:171], v[48:51]
    ds_read_b128 v[124:127], v224 offset:6144
    v_mfma_f32_16x16x32_bf16 v[64:67], v[184:187], v[172:175], v[64:67]
    ds_read_b128 v[128:131], v224 offset:8192
    v_mfma_f32_16x16x32_bf16 v[68:71], v[188:191], v[172:175], v[68:71]
    ds_read_b128 v[132:135], v224 offset:10240
    v_mfma_f32_16x16x32_bf16 v[76:79], v[196:199], v[172:175], v[76:79]
    ds_read_b128 v[136:139], v224 offset:12288
    v_mfma_f32_16x16x32_bf16 v[92:95], v[196:199], v[176:179], v[92:95]
    s_cselect_b32 s69, s67, 0
    v_mfma_f32_16x16x32_bf16 v[84:87], v[188:191], v[176:179], v[84:87]
    s_cselect_b32 s67, 0, s67
    v_mfma_f32_16x16x32_bf16 v[80:83], v[184:187], v[176:179], v[80:83]
    s_mov_b64 s[36:37], s[46:47]
    v_mfma_f32_16x16x32_bf16 v[96:99], v[184:187], v[180:183], v[96:99]
    s_mov_b32 s38, 2621440
    v_mfma_f32_16x16x32_bf16 v[100:103], v[188:191], v[180:183], v[100:103]
    s_mov_b32 s39, 0x20000
    v_mfma_f32_16x16x32_bf16 v[108:111], v[196:199], v[180:183], v[108:111]
    v_mfma_f32_16x16x32_bf16 v[8:11], v[156:159], v[192:195], v[8:11]
    v_mfma_f32_16x16x32_bf16 v[24:27], v[160:163], v[192:195], v[24:27]
    v_mfma_f32_16x16x32_bf16 v[40:43], v[164:167], v[192:195], v[40:43]
    v_mfma_f32_16x16x32_bf16 v[56:59], v[168:171], v[192:195], v[56:59]
    v_mfma_f32_16x16x32_bf16 v[72:75], v[172:175], v[192:195], v[72:75]
    v_mfma_f32_16x16x32_bf16 v[88:91], v[176:179], v[192:195], v[88:91]
    v_mfma_f32_16x16x32_bf16 v[104:107], v[180:183], v[192:195], v[104:107]
.p2align 3
    s_waitcnt lgkmcnt(0)
    s_barrier
    v_mfma_f32_16x16x32_bf16 v[0:3], v[140:143], v[112:115], v[0:3]
    ds_read_b64_tr_b16 v[184:185], v226 offset:15360
    v_mfma_f32_16x16x32_bf16 v[4:7], v[144:147], v[112:115], v[4:7]
    ds_read_b64_tr_b16 v[186:187], v227 offset:15360
    v_mfma_f32_16x16x32_bf16 v[12:15], v[152:155], v[112:115], v[12:15]
    ds_read_b64_tr_b16 v[188:189], v226 offset:20480
    v_mfma_f32_16x16x32_bf16 v[28:31], v[152:155], v[116:119], v[28:31]
    ds_read_b64_tr_b16 v[190:191], v227 offset:20480
    v_mfma_f32_16x16x32_bf16 v[20:23], v[144:147], v[116:119], v[20:23]
    ds_read_b64_tr_b16 v[192:193], v226 offset:25600
    v_mfma_f32_16x16x32_bf16 v[16:19], v[140:143], v[116:119], v[16:19]
    ds_read_b64_tr_b16 v[194:195], v227 offset:25600
    v_mfma_f32_16x16x32_bf16 v[32:35], v[140:143], v[120:123], v[32:35]
    ds_read_b64_tr_b16 v[196:197], v228 offset:15360
    v_mfma_f32_16x16x32_bf16 v[36:39], v[144:147], v[120:123], v[36:39]
    ds_read_b64_tr_b16 v[198:199], v229 offset:15360
    v_mfma_f32_16x16x32_bf16 v[44:47], v[152:155], v[120:123], v[44:47]
    ds_read_b128 v[156:159], v225 offset:0
    v_mfma_f32_16x16x32_bf16 v[60:63], v[152:155], v[124:127], v[60:63]
    ds_read_b128 v[160:163], v225 offset:2048
    v_mfma_f32_16x16x32_bf16 v[52:55], v[144:147], v[124:127], v[52:55]
    ds_read_b128 v[164:167], v225 offset:4096
    v_mfma_f32_16x16x32_bf16 v[48:51], v[140:143], v[124:127], v[48:51]
    ds_read_b128 v[168:171], v225 offset:6144
    v_mfma_f32_16x16x32_bf16 v[64:67], v[140:143], v[128:131], v[64:67]
    ds_read_b128 v[172:175], v225 offset:8192
    v_mfma_f32_16x16x32_bf16 v[68:71], v[144:147], v[128:131], v[68:71]
    ds_read_b128 v[176:179], v225 offset:10240
    v_mfma_f32_16x16x32_bf16 v[76:79], v[152:155], v[128:131], v[76:79]
    ds_read_b128 v[180:183], v225 offset:12288
    v_mfma_f32_16x16x32_bf16 v[92:95], v[152:155], v[132:135], v[92:95]
    v_mfma_f32_16x16x32_bf16 v[84:87], v[144:147], v[132:135], v[84:87]
    v_mfma_f32_16x16x32_bf16 v[80:83], v[140:143], v[132:135], v[80:83]
    v_mfma_f32_16x16x32_bf16 v[96:99], v[140:143], v[136:139], v[96:99]
    v_mfma_f32_16x16x32_bf16 v[100:103], v[144:147], v[136:139], v[100:103]
    v_mfma_f32_16x16x32_bf16 v[108:111], v[152:155], v[136:139], v[108:111]
    v_mfma_f32_16x16x32_bf16 v[8:11], v[112:115], v[148:151], v[8:11]
    v_mfma_f32_16x16x32_bf16 v[24:27], v[116:119], v[148:151], v[24:27]
    v_mfma_f32_16x16x32_bf16 v[40:43], v[120:123], v[148:151], v[40:43]
    v_mfma_f32_16x16x32_bf16 v[56:59], v[124:127], v[148:151], v[56:59]
    v_mfma_f32_16x16x32_bf16 v[72:75], v[128:131], v[148:151], v[72:75]
    v_mfma_f32_16x16x32_bf16 v[88:91], v[132:135], v[148:151], v[88:91]
    v_mfma_f32_16x16x32_bf16 v[104:107], v[136:139], v[148:151], v[104:107]
.p2align 3
    s_waitcnt lgkmcnt(0)
    s_barrier
    v_mfma_f32_16x16x32_bf16 v[0:3], v[184:187], v[156:159], v[0:3]
    ds_read_b64_tr_b16 v[140:141], v226 offset:30720
    v_mfma_f32_16x16x32_bf16 v[4:7], v[188:191], v[156:159], v[4:7]
    ds_read_b64_tr_b16 v[142:143], v227 offset:30720
    v_mfma_f32_16x16x32_bf16 v[12:15], v[196:199], v[156:159], v[12:15]
    ds_read_b64_tr_b16 v[144:145], v226 offset:35840
    v_mfma_f32_16x16x32_bf16 v[28:31], v[196:199], v[160:163], v[28:31]
    ds_read_b64_tr_b16 v[146:147], v227 offset:35840
    v_mfma_f32_16x16x32_bf16 v[20:23], v[188:191], v[160:163], v[20:23]
    ds_read_b64_tr_b16 v[148:149], v226 offset:40960
    v_mfma_f32_16x16x32_bf16 v[16:19], v[184:187], v[160:163], v[16:19]
    ds_read_b64_tr_b16 v[150:151], v227 offset:40960
    v_mfma_f32_16x16x32_bf16 v[32:35], v[184:187], v[164:167], v[32:35]
    ds_read_b64_tr_b16 v[152:153], v228 offset:30720
    v_mfma_f32_16x16x32_bf16 v[36:39], v[188:191], v[164:167], v[36:39]
    ds_read_b64_tr_b16 v[154:155], v229 offset:30720
    v_mfma_f32_16x16x32_bf16 v[44:47], v[196:199], v[164:167], v[44:47]
    ds_read_b128 v[112:115], v224 offset:14336
    v_mfma_f32_16x16x32_bf16 v[60:63], v[196:199], v[168:171], v[60:63]
    ds_read_b128 v[116:119], v224 offset:16384
    v_mfma_f32_16x16x32_bf16 v[52:55], v[188:191], v[168:171], v[52:55]
    ds_read_b128 v[120:123], v224 offset:18432
    v_mfma_f32_16x16x32_bf16 v[48:51], v[184:187], v[168:171], v[48:51]
    ds_read_b128 v[124:127], v224 offset:20480
    v_mfma_f32_16x16x32_bf16 v[64:67], v[184:187], v[172:175], v[64:67]
    ds_read_b128 v[128:131], v224 offset:22528
    v_mfma_f32_16x16x32_bf16 v[68:71], v[188:191], v[172:175], v[68:71]
    ds_read_b128 v[132:135], v224 offset:24576
    v_mfma_f32_16x16x32_bf16 v[76:79], v[196:199], v[172:175], v[76:79]
    ds_read_b128 v[136:139], v224 offset:26624
    v_mfma_f32_16x16x32_bf16 v[92:95], v[196:199], v[176:179], v[92:95]
    v_mfma_f32_16x16x32_bf16 v[84:87], v[188:191], v[176:179], v[84:87]
    v_mfma_f32_16x16x32_bf16 v[80:83], v[184:187], v[176:179], v[80:83]
    v_mfma_f32_16x16x32_bf16 v[96:99], v[184:187], v[180:183], v[96:99]
    v_mfma_f32_16x16x32_bf16 v[100:103], v[188:191], v[180:183], v[100:103]
    v_mfma_f32_16x16x32_bf16 v[108:111], v[196:199], v[180:183], v[108:111]
    v_mfma_f32_16x16x32_bf16 v[8:11], v[156:159], v[192:195], v[8:11]
    v_mfma_f32_16x16x32_bf16 v[24:27], v[160:163], v[192:195], v[24:27]
    v_mfma_f32_16x16x32_bf16 v[40:43], v[164:167], v[192:195], v[40:43]
    v_mfma_f32_16x16x32_bf16 v[56:59], v[168:171], v[192:195], v[56:59]
    v_mfma_f32_16x16x32_bf16 v[72:75], v[172:175], v[192:195], v[72:75]
    v_mfma_f32_16x16x32_bf16 v[88:91], v[176:179], v[192:195], v[88:91]
    v_mfma_f32_16x16x32_bf16 v[104:107], v[180:183], v[192:195], v[104:107]
.p2align 3
    s_waitcnt lgkmcnt(0)
    s_barrier
    v_mfma_f32_16x16x32_bf16 v[0:3], v[140:143], v[112:115], v[0:3]
    ds_read_b64_tr_b16 v[184:185], v226 offset:46080
    v_mfma_f32_16x16x32_bf16 v[4:7], v[144:147], v[112:115], v[4:7]
    ds_read_b64_tr_b16 v[186:187], v227 offset:46080
    v_mfma_f32_16x16x32_bf16 v[12:15], v[152:155], v[112:115], v[12:15]
    ds_read_b64_tr_b16 v[188:189], v226 offset:51200
    v_mfma_f32_16x16x32_bf16 v[28:31], v[152:155], v[116:119], v[28:31]
    ds_read_b64_tr_b16 v[190:191], v227 offset:51200
    v_mfma_f32_16x16x32_bf16 v[20:23], v[144:147], v[116:119], v[20:23]
    ds_read_b64_tr_b16 v[192:193], v226 offset:56320
    v_mfma_f32_16x16x32_bf16 v[16:19], v[140:143], v[116:119], v[16:19]
    ds_read_b64_tr_b16 v[194:195], v227 offset:56320
    v_mfma_f32_16x16x32_bf16 v[32:35], v[140:143], v[120:123], v[32:35]
    ds_read_b64_tr_b16 v[196:197], v228 offset:46080
    v_mfma_f32_16x16x32_bf16 v[36:39], v[144:147], v[120:123], v[36:39]
    ds_read_b64_tr_b16 v[198:199], v229 offset:46080
    v_mfma_f32_16x16x32_bf16 v[44:47], v[152:155], v[120:123], v[44:47]
    ds_read_b128 v[156:159], v225 offset:14336
    v_mfma_f32_16x16x32_bf16 v[60:63], v[152:155], v[124:127], v[60:63]
    ds_read_b128 v[160:163], v225 offset:16384
    v_mfma_f32_16x16x32_bf16 v[52:55], v[144:147], v[124:127], v[52:55]
    ds_read_b128 v[164:167], v225 offset:18432
    v_mfma_f32_16x16x32_bf16 v[48:51], v[140:143], v[124:127], v[48:51]
    ds_read_b128 v[168:171], v225 offset:20480
    v_mfma_f32_16x16x32_bf16 v[64:67], v[140:143], v[128:131], v[64:67]
    ds_read_b128 v[172:175], v225 offset:22528
    v_mfma_f32_16x16x32_bf16 v[68:71], v[144:147], v[128:131], v[68:71]
    ds_read_b128 v[176:179], v225 offset:24576
    v_mfma_f32_16x16x32_bf16 v[76:79], v[152:155], v[128:131], v[76:79]
    ds_read_b128 v[180:183], v225 offset:26624
    v_mfma_f32_16x16x32_bf16 v[92:95], v[152:155], v[132:135], v[92:95]
    v_mfma_f32_16x16x32_bf16 v[84:87], v[144:147], v[132:135], v[84:87]
    v_mfma_f32_16x16x32_bf16 v[80:83], v[140:143], v[132:135], v[80:83]
    v_mfma_f32_16x16x32_bf16 v[96:99], v[140:143], v[136:139], v[96:99]
    v_mfma_f32_16x16x32_bf16 v[100:103], v[144:147], v[136:139], v[100:103]
    v_mfma_f32_16x16x32_bf16 v[108:111], v[152:155], v[136:139], v[108:111]
    v_mfma_f32_16x16x32_bf16 v[8:11], v[112:115], v[148:151], v[8:11]
    v_mfma_f32_16x16x32_bf16 v[24:27], v[116:119], v[148:151], v[24:27]
    v_mfma_f32_16x16x32_bf16 v[40:43], v[120:123], v[148:151], v[40:43]
    v_mfma_f32_16x16x32_bf16 v[56:59], v[124:127], v[148:151], v[56:59]
    v_mfma_f32_16x16x32_bf16 v[72:75], v[128:131], v[148:151], v[72:75]
    v_mfma_f32_16x16x32_bf16 v[88:91], v[132:135], v[148:151], v[88:91]
    v_mfma_f32_16x16x32_bf16 v[104:107], v[136:139], v[148:151], v[104:107]
.p2align 3
    s_waitcnt lgkmcnt(0)
    s_barrier
    v_mfma_f32_16x16x32_bf16 v[0:3], v[184:187], v[156:159], v[0:3]
    ds_read_b64_tr_b16 v[140:141], v226 offset:0
    v_mfma_f32_16x16x32_bf16 v[4:7], v[188:191], v[156:159], v[4:7]
    ds_read_b64_tr_b16 v[142:143], v227 offset:0
    v_mfma_f32_16x16x32_bf16 v[12:15], v[196:199], v[156:159], v[12:15]
    ds_read_b64_tr_b16 v[144:145], v226 offset:5120
    v_mfma_f32_16x16x32_bf16 v[28:31], v[196:199], v[160:163], v[28:31]
    ds_read_b64_tr_b16 v[146:147], v227 offset:5120
    v_mfma_f32_16x16x32_bf16 v[20:23], v[188:191], v[160:163], v[20:23]
    ds_read_b64_tr_b16 v[148:149], v226 offset:10240
    v_mfma_f32_16x16x32_bf16 v[16:19], v[184:187], v[160:163], v[16:19]
    ds_read_b64_tr_b16 v[150:151], v227 offset:10240
    v_mfma_f32_16x16x32_bf16 v[32:35], v[184:187], v[164:167], v[32:35]
    ds_read_b64_tr_b16 v[152:153], v228 offset:0
    v_mfma_f32_16x16x32_bf16 v[36:39], v[188:191], v[164:167], v[36:39]
    ds_read_b64_tr_b16 v[154:155], v229 offset:0
    v_mfma_f32_16x16x32_bf16 v[44:47], v[196:199], v[164:167], v[44:47]
    ds_read_b128 v[112:115], v224 offset:28672
    v_mfma_f32_16x16x32_bf16 v[60:63], v[196:199], v[168:171], v[60:63]
    ds_read_b128 v[116:119], v224 offset:30720
    v_mfma_f32_16x16x32_bf16 v[52:55], v[188:191], v[168:171], v[52:55]
    ds_read_b128 v[120:123], v224 offset:32768
    v_mfma_f32_16x16x32_bf16 v[48:51], v[184:187], v[168:171], v[48:51]
    ds_read_b128 v[124:127], v224 offset:34816
    v_mfma_f32_16x16x32_bf16 v[64:67], v[184:187], v[172:175], v[64:67]
    ds_read_b128 v[128:131], v224 offset:36864
    v_mfma_f32_16x16x32_bf16 v[68:71], v[188:191], v[172:175], v[68:71]
    ds_read_b128 v[132:135], v224 offset:38912
    v_mfma_f32_16x16x32_bf16 v[76:79], v[196:199], v[172:175], v[76:79]
    ds_read_b128 v[136:139], v224 offset:40960
    v_mfma_f32_16x16x32_bf16 v[92:95], v[196:199], v[176:179], v[92:95]
    v_mfma_f32_16x16x32_bf16 v[84:87], v[188:191], v[176:179], v[84:87]
    v_mfma_f32_16x16x32_bf16 v[80:83], v[184:187], v[176:179], v[80:83]
    v_mfma_f32_16x16x32_bf16 v[96:99], v[184:187], v[180:183], v[96:99]
    v_mfma_f32_16x16x32_bf16 v[100:103], v[188:191], v[180:183], v[100:103]
    v_mfma_f32_16x16x32_bf16 v[108:111], v[196:199], v[180:183], v[108:111]
    v_mfma_f32_16x16x32_bf16 v[8:11], v[156:159], v[192:195], v[8:11]
    v_mfma_f32_16x16x32_bf16 v[24:27], v[160:163], v[192:195], v[24:27]
    v_mfma_f32_16x16x32_bf16 v[40:43], v[164:167], v[192:195], v[40:43]
    v_mfma_f32_16x16x32_bf16 v[56:59], v[168:171], v[192:195], v[56:59]
    v_mfma_f32_16x16x32_bf16 v[72:75], v[172:175], v[192:195], v[72:75]
    v_mfma_f32_16x16x32_bf16 v[88:91], v[176:179], v[192:195], v[88:91]
    v_mfma_f32_16x16x32_bf16 v[104:107], v[180:183], v[192:195], v[104:107]
.p2align 3
    s_waitcnt lgkmcnt(0)
    s_barrier
    v_mfma_f32_16x16x32_bf16 v[0:3], v[140:143], v[112:115], v[0:3]
    ds_read_b64_tr_b16 v[184:185], v226 offset:15360
    v_mfma_f32_16x16x32_bf16 v[4:7], v[144:147], v[112:115], v[4:7]
    ds_read_b64_tr_b16 v[186:187], v227 offset:15360
    v_mfma_f32_16x16x32_bf16 v[12:15], v[152:155], v[112:115], v[12:15]
    ds_read_b64_tr_b16 v[188:189], v226 offset:20480
    v_mfma_f32_16x16x32_bf16 v[28:31], v[152:155], v[116:119], v[28:31]
    ds_read_b64_tr_b16 v[190:191], v227 offset:20480
    v_mfma_f32_16x16x32_bf16 v[20:23], v[144:147], v[116:119], v[20:23]
    ds_read_b64_tr_b16 v[192:193], v226 offset:25600
    v_mfma_f32_16x16x32_bf16 v[16:19], v[140:143], v[116:119], v[16:19]
    ds_read_b64_tr_b16 v[194:195], v227 offset:25600
    v_mfma_f32_16x16x32_bf16 v[32:35], v[140:143], v[120:123], v[32:35]
    ds_read_b64_tr_b16 v[196:197], v228 offset:15360
    v_mfma_f32_16x16x32_bf16 v[36:39], v[144:147], v[120:123], v[36:39]
    ds_read_b64_tr_b16 v[198:199], v229 offset:15360
    v_mfma_f32_16x16x32_bf16 v[44:47], v[152:155], v[120:123], v[44:47]
    ds_read_b128 v[156:159], v225 offset:28672
    v_mfma_f32_16x16x32_bf16 v[60:63], v[152:155], v[124:127], v[60:63]
    ds_read_b128 v[160:163], v225 offset:30720
    v_mfma_f32_16x16x32_bf16 v[52:55], v[144:147], v[124:127], v[52:55]
    ds_read_b128 v[164:167], v225 offset:32768
    v_mfma_f32_16x16x32_bf16 v[48:51], v[140:143], v[124:127], v[48:51]
    ds_read_b128 v[168:171], v225 offset:34816
    v_mfma_f32_16x16x32_bf16 v[64:67], v[140:143], v[128:131], v[64:67]
    ds_read_b128 v[172:175], v225 offset:36864
    v_mfma_f32_16x16x32_bf16 v[68:71], v[144:147], v[128:131], v[68:71]
    ds_read_b128 v[176:179], v225 offset:38912
    v_mfma_f32_16x16x32_bf16 v[76:79], v[152:155], v[128:131], v[76:79]
    ds_read_b128 v[180:183], v225 offset:40960
    v_mfma_f32_16x16x32_bf16 v[92:95], v[152:155], v[132:135], v[92:95]
    v_mfma_f32_16x16x32_bf16 v[84:87], v[144:147], v[132:135], v[84:87]
    v_mfma_f32_16x16x32_bf16 v[80:83], v[140:143], v[132:135], v[80:83]
    v_mfma_f32_16x16x32_bf16 v[96:99], v[140:143], v[136:139], v[96:99]
    v_mfma_f32_16x16x32_bf16 v[100:103], v[144:147], v[136:139], v[100:103]
    v_mfma_f32_16x16x32_bf16 v[108:111], v[152:155], v[136:139], v[108:111]
    v_mfma_f32_16x16x32_bf16 v[8:11], v[112:115], v[148:151], v[8:11]
    v_mfma_f32_16x16x32_bf16 v[24:27], v[116:119], v[148:151], v[24:27]
    v_mfma_f32_16x16x32_bf16 v[40:43], v[120:123], v[148:151], v[40:43]
    v_mfma_f32_16x16x32_bf16 v[56:59], v[124:127], v[148:151], v[56:59]
    v_mfma_f32_16x16x32_bf16 v[72:75], v[128:131], v[148:151], v[72:75]
    v_mfma_f32_16x16x32_bf16 v[88:91], v[132:135], v[148:151], v[88:91]
    v_mfma_f32_16x16x32_bf16 v[104:107], v[136:139], v[148:151], v[104:107]
.p2align 3
    s_waitcnt lgkmcnt(0)
    s_barrier
    v_mfma_f32_16x16x32_bf16 v[0:3], v[184:187], v[156:159], v[0:3]
    ds_read_b64_tr_b16 v[140:141], v226 offset:30720
    v_mfma_f32_16x16x32_bf16 v[4:7], v[188:191], v[156:159], v[4:7]
    ds_read_b64_tr_b16 v[142:143], v227 offset:30720
    v_mfma_f32_16x16x32_bf16 v[12:15], v[196:199], v[156:159], v[12:15]
    ds_read_b64_tr_b16 v[144:145], v226 offset:35840
    v_mfma_f32_16x16x32_bf16 v[28:31], v[196:199], v[160:163], v[28:31]
    ds_read_b64_tr_b16 v[146:147], v227 offset:35840
    v_mfma_f32_16x16x32_bf16 v[20:23], v[188:191], v[160:163], v[20:23]
    ds_read_b64_tr_b16 v[148:149], v226 offset:40960
    v_mfma_f32_16x16x32_bf16 v[16:19], v[184:187], v[160:163], v[16:19]
    ds_read_b64_tr_b16 v[150:151], v227 offset:40960
    v_mfma_f32_16x16x32_bf16 v[32:35], v[184:187], v[164:167], v[32:35]
    ds_read_b64_tr_b16 v[152:153], v228 offset:30720
    v_mfma_f32_16x16x32_bf16 v[36:39], v[188:191], v[164:167], v[36:39]
    ds_read_b64_tr_b16 v[154:155], v229 offset:30720
    v_mfma_f32_16x16x32_bf16 v[44:47], v[196:199], v[164:167], v[44:47]
    ds_read_b128 v[112:115], v224 offset:0
    v_mfma_f32_16x16x32_bf16 v[60:63], v[196:199], v[168:171], v[60:63]
    ds_read_b128 v[116:119], v224 offset:2048
    v_mfma_f32_16x16x32_bf16 v[52:55], v[188:191], v[168:171], v[52:55]
    ds_read_b128 v[120:123], v224 offset:4096
    v_mfma_f32_16x16x32_bf16 v[48:51], v[184:187], v[168:171], v[48:51]
    ds_read_b128 v[124:127], v224 offset:6144
    v_mfma_f32_16x16x32_bf16 v[64:67], v[184:187], v[172:175], v[64:67]
    ds_read_b128 v[128:131], v224 offset:8192
    v_mfma_f32_16x16x32_bf16 v[68:71], v[188:191], v[172:175], v[68:71]
    ds_read_b128 v[132:135], v224 offset:10240
    v_mfma_f32_16x16x32_bf16 v[76:79], v[196:199], v[172:175], v[76:79]
    ds_read_b128 v[136:139], v224 offset:12288
    v_mfma_f32_16x16x32_bf16 v[92:95], v[196:199], v[176:179], v[92:95]
    v_mfma_f32_16x16x32_bf16 v[84:87], v[188:191], v[176:179], v[84:87]
    v_mfma_f32_16x16x32_bf16 v[80:83], v[184:187], v[176:179], v[80:83]
    v_mfma_f32_16x16x32_bf16 v[96:99], v[184:187], v[180:183], v[96:99]
    v_mfma_f32_16x16x32_bf16 v[100:103], v[188:191], v[180:183], v[100:103]
    v_mfma_f32_16x16x32_bf16 v[108:111], v[196:199], v[180:183], v[108:111]
    v_mfma_f32_16x16x32_bf16 v[8:11], v[156:159], v[192:195], v[8:11]
    v_mfma_f32_16x16x32_bf16 v[24:27], v[160:163], v[192:195], v[24:27]
    v_mfma_f32_16x16x32_bf16 v[40:43], v[164:167], v[192:195], v[40:43]
    v_mfma_f32_16x16x32_bf16 v[56:59], v[168:171], v[192:195], v[56:59]
    v_mfma_f32_16x16x32_bf16 v[72:75], v[172:175], v[192:195], v[72:75]
    v_mfma_f32_16x16x32_bf16 v[88:91], v[176:179], v[192:195], v[88:91]
    v_mfma_f32_16x16x32_bf16 v[104:107], v[180:183], v[192:195], v[104:107]
.p2align 3
    s_waitcnt lgkmcnt(0)
    s_barrier
    v_mfma_f32_16x16x32_bf16 v[0:3], v[140:143], v[112:115], v[0:3]
    ds_read_b64_tr_b16 v[184:185], v226 offset:46080
    v_mfma_f32_16x16x32_bf16 v[4:7], v[144:147], v[112:115], v[4:7]
    ds_read_b64_tr_b16 v[186:187], v227 offset:46080
    v_mfma_f32_16x16x32_bf16 v[12:15], v[152:155], v[112:115], v[12:15]
    ds_read_b64_tr_b16 v[188:189], v226 offset:51200
    v_mfma_f32_16x16x32_bf16 v[28:31], v[152:155], v[116:119], v[28:31]
    ds_read_b64_tr_b16 v[190:191], v227 offset:51200
    v_mfma_f32_16x16x32_bf16 v[20:23], v[144:147], v[116:119], v[20:23]
    ds_read_b64_tr_b16 v[192:193], v226 offset:56320
    v_mfma_f32_16x16x32_bf16 v[16:19], v[140:143], v[116:119], v[16:19]
    ds_read_b64_tr_b16 v[194:195], v227 offset:56320
    v_mfma_f32_16x16x32_bf16 v[32:35], v[140:143], v[120:123], v[32:35]
    ds_read_b64_tr_b16 v[196:197], v228 offset:46080
    v_mfma_f32_16x16x32_bf16 v[36:39], v[144:147], v[120:123], v[36:39]
    ds_read_b64_tr_b16 v[198:199], v229 offset:46080
    v_mfma_f32_16x16x32_bf16 v[44:47], v[152:155], v[120:123], v[44:47]
    ds_read_b128 v[156:159], v225 offset:0
    v_mfma_f32_16x16x32_bf16 v[60:63], v[152:155], v[124:127], v[60:63]
    ds_read_b128 v[160:163], v225 offset:2048
    v_mfma_f32_16x16x32_bf16 v[52:55], v[144:147], v[124:127], v[52:55]
    ds_read_b128 v[164:167], v225 offset:4096
    v_mfma_f32_16x16x32_bf16 v[48:51], v[140:143], v[124:127], v[48:51]
    ds_read_b128 v[168:171], v225 offset:6144
    v_mfma_f32_16x16x32_bf16 v[64:67], v[140:143], v[128:131], v[64:67]
    ds_read_b128 v[172:175], v225 offset:8192
    v_mfma_f32_16x16x32_bf16 v[68:71], v[144:147], v[128:131], v[68:71]
    ds_read_b128 v[176:179], v225 offset:10240
    v_mfma_f32_16x16x32_bf16 v[76:79], v[152:155], v[128:131], v[76:79]
    ds_read_b128 v[180:183], v225 offset:12288
    v_mfma_f32_16x16x32_bf16 v[92:95], v[152:155], v[132:135], v[92:95]
    v_mfma_f32_16x16x32_bf16 v[84:87], v[144:147], v[132:135], v[84:87]
    v_mfma_f32_16x16x32_bf16 v[80:83], v[140:143], v[132:135], v[80:83]
    v_mfma_f32_16x16x32_bf16 v[96:99], v[140:143], v[136:139], v[96:99]
    v_mfma_f32_16x16x32_bf16 v[100:103], v[144:147], v[136:139], v[100:103]
    v_mfma_f32_16x16x32_bf16 v[108:111], v[152:155], v[136:139], v[108:111]
    v_mfma_f32_16x16x32_bf16 v[8:11], v[112:115], v[148:151], v[8:11]
    v_mfma_f32_16x16x32_bf16 v[24:27], v[116:119], v[148:151], v[24:27]
    v_mfma_f32_16x16x32_bf16 v[40:43], v[120:123], v[148:151], v[40:43]
    v_mfma_f32_16x16x32_bf16 v[56:59], v[124:127], v[148:151], v[56:59]
    v_mfma_f32_16x16x32_bf16 v[72:75], v[128:131], v[148:151], v[72:75]
    v_mfma_f32_16x16x32_bf16 v[88:91], v[132:135], v[148:151], v[88:91]
    v_mfma_f32_16x16x32_bf16 v[104:107], v[136:139], v[148:151], v[104:107]
.p2align 3
    s_waitcnt lgkmcnt(0)
    s_barrier
    v_mfma_f32_16x16x32_bf16 v[0:3], v[184:187], v[156:159], v[0:3]
    ds_read_b64_tr_b16 v[140:141], v226 offset:0
    v_mfma_f32_16x16x32_bf16 v[4:7], v[188:191], v[156:159], v[4:7]
    ds_read_b64_tr_b16 v[142:143], v227 offset:0
    v_mfma_f32_16x16x32_bf16 v[12:15], v[196:199], v[156:159], v[12:15]
    ds_read_b64_tr_b16 v[144:145], v226 offset:5120
    v_mfma_f32_16x16x32_bf16 v[28:31], v[196:199], v[160:163], v[28:31]
    ds_read_b64_tr_b16 v[146:147], v227 offset:5120
    v_mfma_f32_16x16x32_bf16 v[20:23], v[188:191], v[160:163], v[20:23]
    ds_read_b64_tr_b16 v[148:149], v226 offset:10240
    v_mfma_f32_16x16x32_bf16 v[16:19], v[184:187], v[160:163], v[16:19]
    ds_read_b64_tr_b16 v[150:151], v227 offset:10240
    v_mfma_f32_16x16x32_bf16 v[32:35], v[184:187], v[164:167], v[32:35]
    ds_read_b64_tr_b16 v[152:153], v228 offset:0
    v_mfma_f32_16x16x32_bf16 v[36:39], v[188:191], v[164:167], v[36:39]
    ds_read_b64_tr_b16 v[154:155], v229 offset:0
    v_mfma_f32_16x16x32_bf16 v[44:47], v[196:199], v[164:167], v[44:47]
    ds_read_b128 v[112:115], v224 offset:14336
    v_mfma_f32_16x16x32_bf16 v[60:63], v[196:199], v[168:171], v[60:63]
    ds_read_b128 v[116:119], v224 offset:16384
    v_mfma_f32_16x16x32_bf16 v[52:55], v[188:191], v[168:171], v[52:55]
    ds_read_b128 v[120:123], v224 offset:18432
    v_mfma_f32_16x16x32_bf16 v[48:51], v[184:187], v[168:171], v[48:51]
    ds_read_b128 v[124:127], v224 offset:20480
    v_mfma_f32_16x16x32_bf16 v[64:67], v[184:187], v[172:175], v[64:67]
    ds_read_b128 v[128:131], v224 offset:22528
    v_mfma_f32_16x16x32_bf16 v[68:71], v[188:191], v[172:175], v[68:71]
    ds_read_b128 v[132:135], v224 offset:24576
    v_mfma_f32_16x16x32_bf16 v[76:79], v[196:199], v[172:175], v[76:79]
    ds_read_b128 v[136:139], v224 offset:26624
    v_mfma_f32_16x16x32_bf16 v[92:95], v[196:199], v[176:179], v[92:95]
    v_mfma_f32_16x16x32_bf16 v[84:87], v[188:191], v[176:179], v[84:87]
    v_mfma_f32_16x16x32_bf16 v[80:83], v[184:187], v[176:179], v[80:83]
    v_mfma_f32_16x16x32_bf16 v[96:99], v[184:187], v[180:183], v[96:99]
    v_mfma_f32_16x16x32_bf16 v[100:103], v[188:191], v[180:183], v[100:103]
    v_mfma_f32_16x16x32_bf16 v[108:111], v[196:199], v[180:183], v[108:111]
    v_mfma_f32_16x16x32_bf16 v[8:11], v[156:159], v[192:195], v[8:11]
    v_mfma_f32_16x16x32_bf16 v[24:27], v[160:163], v[192:195], v[24:27]
    v_mfma_f32_16x16x32_bf16 v[40:43], v[164:167], v[192:195], v[40:43]
    v_mfma_f32_16x16x32_bf16 v[56:59], v[168:171], v[192:195], v[56:59]
    v_mfma_f32_16x16x32_bf16 v[72:75], v[172:175], v[192:195], v[72:75]
    v_mfma_f32_16x16x32_bf16 v[88:91], v[176:179], v[192:195], v[88:91]
    v_mfma_f32_16x16x32_bf16 v[104:107], v[180:183], v[192:195], v[104:107]
.p2align 3
    s_waitcnt lgkmcnt(0)
    s_barrier
    v_mfma_f32_16x16x32_bf16 v[0:3], v[140:143], v[112:115], v[0:3]
    ds_read_b64_tr_b16 v[184:185], v226 offset:15360
    v_mfma_f32_16x16x32_bf16 v[4:7], v[144:147], v[112:115], v[4:7]
    ds_read_b64_tr_b16 v[186:187], v227 offset:15360
    v_mfma_f32_16x16x32_bf16 v[12:15], v[152:155], v[112:115], v[12:15]
    ds_read_b64_tr_b16 v[188:189], v226 offset:20480
    v_mfma_f32_16x16x32_bf16 v[28:31], v[152:155], v[116:119], v[28:31]
    ds_read_b64_tr_b16 v[190:191], v227 offset:20480
    v_mfma_f32_16x16x32_bf16 v[20:23], v[144:147], v[116:119], v[20:23]
    ds_read_b64_tr_b16 v[192:193], v226 offset:25600
    v_mfma_f32_16x16x32_bf16 v[16:19], v[140:143], v[116:119], v[16:19]
    ds_read_b64_tr_b16 v[194:195], v227 offset:25600
    v_mfma_f32_16x16x32_bf16 v[32:35], v[140:143], v[120:123], v[32:35]
    ds_read_b64_tr_b16 v[196:197], v228 offset:15360
    v_mfma_f32_16x16x32_bf16 v[36:39], v[144:147], v[120:123], v[36:39]
    ds_read_b64_tr_b16 v[198:199], v229 offset:15360
    v_mfma_f32_16x16x32_bf16 v[44:47], v[152:155], v[120:123], v[44:47]
    ds_read_b128 v[156:159], v225 offset:14336
    v_mfma_f32_16x16x32_bf16 v[60:63], v[152:155], v[124:127], v[60:63]
    ds_read_b128 v[160:163], v225 offset:16384
    v_mfma_f32_16x16x32_bf16 v[52:55], v[144:147], v[124:127], v[52:55]
    ds_read_b128 v[164:167], v225 offset:18432
    v_mfma_f32_16x16x32_bf16 v[48:51], v[140:143], v[124:127], v[48:51]
    ds_read_b128 v[168:171], v225 offset:20480
    v_mfma_f32_16x16x32_bf16 v[64:67], v[140:143], v[128:131], v[64:67]
    ds_read_b128 v[172:175], v225 offset:22528
    v_mfma_f32_16x16x32_bf16 v[68:71], v[144:147], v[128:131], v[68:71]
    ds_read_b128 v[176:179], v225 offset:24576
    v_mfma_f32_16x16x32_bf16 v[76:79], v[152:155], v[128:131], v[76:79]
    ds_read_b128 v[180:183], v225 offset:26624
    v_mfma_f32_16x16x32_bf16 v[92:95], v[152:155], v[132:135], v[92:95]
    v_mfma_f32_16x16x32_bf16 v[84:87], v[144:147], v[132:135], v[84:87]
    v_mfma_f32_16x16x32_bf16 v[80:83], v[140:143], v[132:135], v[80:83]
    v_mfma_f32_16x16x32_bf16 v[96:99], v[140:143], v[136:139], v[96:99]
    v_mfma_f32_16x16x32_bf16 v[100:103], v[144:147], v[136:139], v[100:103]
    v_mfma_f32_16x16x32_bf16 v[108:111], v[152:155], v[136:139], v[108:111]
    v_mfma_f32_16x16x32_bf16 v[8:11], v[112:115], v[148:151], v[8:11]
    v_mfma_f32_16x16x32_bf16 v[24:27], v[116:119], v[148:151], v[24:27]
    v_mfma_f32_16x16x32_bf16 v[40:43], v[120:123], v[148:151], v[40:43]
    v_mfma_f32_16x16x32_bf16 v[56:59], v[124:127], v[148:151], v[56:59]
    v_mfma_f32_16x16x32_bf16 v[72:75], v[128:131], v[148:151], v[72:75]
    v_mfma_f32_16x16x32_bf16 v[88:91], v[132:135], v[148:151], v[88:91]
    v_mfma_f32_16x16x32_bf16 v[104:107], v[136:139], v[148:151], v[104:107]
.p2align 3
    s_waitcnt lgkmcnt(0)
    s_barrier
    v_mfma_f32_16x16x32_bf16 v[0:3], v[184:187], v[156:159], v[0:3]
    ds_read_b64_tr_b16 v[140:141], v226 offset:30720
    v_mfma_f32_16x16x32_bf16 v[4:7], v[188:191], v[156:159], v[4:7]
    ds_read_b64_tr_b16 v[142:143], v227 offset:30720
    v_mfma_f32_16x16x32_bf16 v[12:15], v[196:199], v[156:159], v[12:15]
    ds_read_b64_tr_b16 v[144:145], v226 offset:35840
    v_mfma_f32_16x16x32_bf16 v[28:31], v[196:199], v[160:163], v[28:31]
    ds_read_b64_tr_b16 v[146:147], v227 offset:35840
    v_mfma_f32_16x16x32_bf16 v[20:23], v[188:191], v[160:163], v[20:23]
    ds_read_b64_tr_b16 v[148:149], v226 offset:40960
    v_mfma_f32_16x16x32_bf16 v[16:19], v[184:187], v[160:163], v[16:19]
    ds_read_b64_tr_b16 v[150:151], v227 offset:40960
    v_mfma_f32_16x16x32_bf16 v[32:35], v[184:187], v[164:167], v[32:35]
    ds_read_b64_tr_b16 v[152:153], v228 offset:30720
    v_mfma_f32_16x16x32_bf16 v[36:39], v[188:191], v[164:167], v[36:39]
    ds_read_b64_tr_b16 v[154:155], v229 offset:30720
    v_mfma_f32_16x16x32_bf16 v[44:47], v[196:199], v[164:167], v[44:47]
    ds_read_b128 v[112:115], v224 offset:28672
    v_mfma_f32_16x16x32_bf16 v[60:63], v[196:199], v[168:171], v[60:63]
    ds_read_b128 v[116:119], v224 offset:30720
    v_mfma_f32_16x16x32_bf16 v[52:55], v[188:191], v[168:171], v[52:55]
    ds_read_b128 v[120:123], v224 offset:32768
    v_mfma_f32_16x16x32_bf16 v[48:51], v[184:187], v[168:171], v[48:51]
    ds_read_b128 v[124:127], v224 offset:34816
    v_mfma_f32_16x16x32_bf16 v[64:67], v[184:187], v[172:175], v[64:67]
    ds_read_b128 v[128:131], v224 offset:36864
    v_mfma_f32_16x16x32_bf16 v[68:71], v[188:191], v[172:175], v[68:71]
    ds_read_b128 v[132:135], v224 offset:38912
    v_mfma_f32_16x16x32_bf16 v[76:79], v[196:199], v[172:175], v[76:79]
    ds_read_b128 v[136:139], v224 offset:40960
    v_mfma_f32_16x16x32_bf16 v[92:95], v[196:199], v[176:179], v[92:95]
    v_mfma_f32_16x16x32_bf16 v[84:87], v[188:191], v[176:179], v[84:87]
    v_mfma_f32_16x16x32_bf16 v[80:83], v[184:187], v[176:179], v[80:83]
    v_mfma_f32_16x16x32_bf16 v[96:99], v[184:187], v[180:183], v[96:99]
    v_mfma_f32_16x16x32_bf16 v[100:103], v[188:191], v[180:183], v[100:103]
    v_mfma_f32_16x16x32_bf16 v[108:111], v[196:199], v[180:183], v[108:111]
    v_mfma_f32_16x16x32_bf16 v[8:11], v[156:159], v[192:195], v[8:11]
    v_mfma_f32_16x16x32_bf16 v[24:27], v[160:163], v[192:195], v[24:27]
    v_mfma_f32_16x16x32_bf16 v[40:43], v[164:167], v[192:195], v[40:43]
    v_mfma_f32_16x16x32_bf16 v[56:59], v[168:171], v[192:195], v[56:59]
    v_mfma_f32_16x16x32_bf16 v[72:75], v[172:175], v[192:195], v[72:75]
    v_mfma_f32_16x16x32_bf16 v[88:91], v[176:179], v[192:195], v[88:91]
    v_mfma_f32_16x16x32_bf16 v[104:107], v[180:183], v[192:195], v[104:107]
.p2align 3
    s_waitcnt lgkmcnt(0)
    s_barrier
    v_mfma_f32_16x16x32_bf16 v[0:3], v[140:143], v[112:115], v[0:3]
    ds_read_b64_tr_b16 v[184:185], v226 offset:46080
    ds_read_b64_tr_b16 v[186:187], v227 offset:46080
    v_mfma_f32_16x16x32_bf16 v[4:7], v[144:147], v[112:115], v[4:7]
    ds_read_b64_tr_b16 v[188:189], v226 offset:51200
    ds_read_b64_tr_b16 v[190:191], v227 offset:51200
    v_mfma_f32_16x16x32_bf16 v[8:11], v[112:115], v[148:151], v[8:11]
    ds_read_b64_tr_b16 v[192:193], v226 offset:56320
    ds_read_b64_tr_b16 v[194:195], v227 offset:56320
    v_mfma_f32_16x16x32_bf16 v[12:15], v[152:155], v[112:115], v[12:15]
    ds_read_b64_tr_b16 v[196:197], v228 offset:46080
    ds_read_b64_tr_b16 v[198:199], v229 offset:46080
    v_mfma_f32_16x16x32_bf16 v[16:19], v[140:143], v[116:119], v[16:19]
    ds_read_b128 v[156:159], v225 offset:28672
    ds_read_b128 v[160:163], v225 offset:30720
    v_mfma_f32_16x16x32_bf16 v[20:23], v[144:147], v[116:119], v[20:23]
    ds_read_b128 v[164:167], v225 offset:32768
    ds_read_b128 v[168:171], v225 offset:34816
    v_mfma_f32_16x16x32_bf16 v[24:27], v[116:119], v[148:151], v[24:27]
    ds_read_b128 v[172:175], v225 offset:36864
    ds_read_b128 v[176:179], v225 offset:38912
    v_mfma_f32_16x16x32_bf16 v[28:31], v[152:155], v[116:119], v[28:31]
    ds_read_b128 v[180:183], v225 offset:40960
    v_mfma_f32_16x16x32_bf16 v[32:35], v[140:143], v[120:123], v[32:35]
    v_mfma_f32_16x16x32_bf16 v[36:39], v[144:147], v[120:123], v[36:39]
    v_mfma_f32_16x16x32_bf16 v[40:43], v[120:123], v[148:151], v[40:43]
    v_mfma_f32_16x16x32_bf16 v[44:47], v[152:155], v[120:123], v[44:47]
    v_mfma_f32_16x16x32_bf16 v[48:51], v[140:143], v[124:127], v[48:51]
    v_mfma_f32_16x16x32_bf16 v[52:55], v[144:147], v[124:127], v[52:55]
    v_mfma_f32_16x16x32_bf16 v[56:59], v[124:127], v[148:151], v[56:59]
    v_mfma_f32_16x16x32_bf16 v[60:63], v[152:155], v[124:127], v[60:63]
.p2align 3
    s_waitcnt vmcnt(0) lgkmcnt(0)
    s_barrier
    v_mfma_f32_16x16x32_bf16 v[4:7], v[188:191], v[156:159], v[4:7]
    v_mfma_f32_16x16x32_bf16 v[32:35], v[184:187], v[164:167], v[32:35]
    v_mfma_f32_16x16x32_bf16 v[36:39], v[188:191], v[164:167], v[36:39]
    v_mfma_f32_16x16x32_bf16 v[52:55], v[188:191], v[168:171], v[52:55]
    v_mfma_f32_16x16x32_bf16 v[0:3], v[184:187], v[156:159], v[0:3]
    v_mfma_f32_16x16x32_bf16 v[16:19], v[184:187], v[160:163], v[16:19]
    v_mfma_f32_16x16x32_bf16 v[44:47], v[196:199], v[164:167], v[44:47]
    v_mfma_f32_16x16x32_bf16 v[12:15], v[196:199], v[156:159], v[12:15]
    s_nop 0
    v_cvt_pk_bf16_f32 v4, v4, v5
    v_mfma_f32_16x16x32_bf16 v[20:23], v[188:191], v[160:163], v[20:23]
    v_cvt_pk_bf16_f32 v32, v32, v33
    v_cvt_pk_bf16_f32 v52, v52, v53
    v_mfma_f32_16x16x32_bf16 v[48:51], v[184:187], v[168:171], v[48:51]
    v_cvt_pk_bf16_f32 v16, v16, v17
    v_cvt_pk_bf16_f32 v0, v0, v1
    v_mfma_f32_16x16x32_bf16 v[60:63], v[196:199], v[168:171], v[60:63]
    v_cvt_pk_bf16_f32 v1, v2, v3
    v_cvt_pk_bf16_f32 v3, v14, v15
    v_mfma_f32_16x16x32_bf16 v[28:31], v[196:199], v[160:163], v[28:31]
    v_cvt_pk_bf16_f32 v20, v20, v21
    v_cvt_pk_bf16_f32 v21, v22, v23
    v_mfma_f32_16x16x32_bf16 v[40:43], v[164:167], v[192:195], v[40:43]
    v_cvt_pk_bf16_f32 v48, v48, v49
    v_cvt_pk_bf16_f32 v49, v50, v51
    v_mfma_f32_16x16x32_bf16 v[56:59], v[168:171], v[192:195], v[56:59]
    v_cvt_pk_bf16_f32 v2, v12, v13
    v_cvt_pk_bf16_f32 v17, v18, v19
    v_mfma_f32_16x16x32_bf16 v[8:11], v[156:159], v[192:195], v[8:11]
    v_cvt_pk_bf16_f32 v18, v28, v29
    v_cvt_pk_bf16_f32 v36, v36, v37
    v_mfma_f32_16x16x32_bf16 v[24:27], v[160:163], v[192:195], v[24:27]
    v_cvt_pk_bf16_f32 v5, v6, v7
    v_cvt_pk_bf16_f32 v53, v54, v55
    v_mfma_f32_16x16x32_bf16 v[76:79], v[152:155], v[128:131], v[76:79]
    v_cvt_pk_bf16_f32 v33, v34, v35
    v_mov_b64 v[22:23], 0
    v_mfma_f32_16x16x32_bf16 v[72:75], v[128:131], v[148:151], v[72:75]
    v_cvt_pk_bf16_f32 v51, v62, v63
    v_cvt_pk_bf16_f32 v37, v38, v39
    v_mfma_f32_16x16x32_bf16 v[64:67], v[140:143], v[128:131], v[64:67]
    v_mov_b64_e64 v[38:39], 0
    v_cvt_pk_bf16_f32 v35, v46, v47
    v_mfma_f32_16x16x32_bf16 v[68:71], v[144:147], v[128:131], v[68:71]
    v_cvt_pk_bf16_f32 v34, v44, v45
    v_mov_b64_e64 v[6:7], 0
    v_mfma_f32_16x16x32_bf16 v[88:91], v[132:135], v[148:151], v[88:91]
    v_mov_b64_e64 v[54:55], 0
    v_cvt_pk_bf16_f32 v19, v30, v31
    v_mfma_f32_16x16x32_bf16 v[80:83], v[140:143], v[132:135], v[80:83]
    v_permlane32_swap_b32_e64 v34, v38
    v_mfma_f32_16x16x32_bf16 v[92:95], v[152:155], v[132:135], v[92:95]
    v_permlane32_swap_b32_e64 v19, v23
    v_mfma_f32_16x16x32_bf16 v[84:87], v[144:147], v[132:135], v[84:87]
    v_cvt_pk_bf16_f32 v50, v60, v61
    v_cvt_pk_bf16_f32 v116, v40, v41
    v_mfma_f32_16x16x32_bf16 v[100:103], v[144:147], v[136:139], v[100:103]
    v_permlane32_swap_b32_e64 v50, v54
    v_mfma_f32_16x16x32_bf16 v[108:111], v[152:155], v[136:139], v[108:111]
    v_permlane32_swap_b32_e64 v18, v22
    v_mfma_f32_16x16x32_bf16 v[96:99], v[140:143], v[136:139], v[96:99]
    v_permlane32_swap_b32_e64 v2, v6
    v_mfma_f32_16x16x16_bf16 v[160:163], v[18:19], v[246:247], v[240:243]
    v_permlane32_swap_b32_e64 v35, v39
    v_mfma_f32_16x16x32_bf16 v[84:87], v[188:191], v[176:179], v[84:87]
    v_permlane32_swap_b32_e64 v51, v55
    v_mfma_f32_16x16x32_bf16 v[44:47], v[20:23], v[32:35], v[236:239]
    v_permlane32_swap_b32_e64 v3, v7
    v_mfma_f32_16x16x32_bf16 v[60:63], v[36:39], v[48:51], v[236:239]
    v_cvt_pk_bf16_f32 v115, v26, v27
    v_cvt_pk_bf16_f32 v113, v10, v11
    v_mfma_f32_16x16x32_bf16 v[28:31], v[4:7], v[16:19], v[236:239]
    v_cvt_pk_bf16_f32 v114, v24, v25
    v_cvt_pk_bf16_f32 v119, v58, v59
    v_mfma_f32_16x16x32_bf16 v[24:27], v[20:23], v[16:19], v[232:235]
    v_cvt_pk_bf16_f32 v117, v42, v43
    v_cvt_pk_bf16_f32 v118, v56, v57
    v_mfma_f32_16x16x32_bf16 v[56:59], v[52:55], v[48:51], v[232:235]
    v_cvt_pk_bf16_f32 v112, v8, v9
    v_cvt_pk_bf16_f32 v130, v160, v161
    v_mfma_f32_16x16x32_bf16 v[8:11], v[4:7], v[0:3], v[232:235]
    v_cvt_pk_bf16_f32 v131, v162, v163
    v_cvt_pk_bf16_f32 v84, v84, v85
    v_mfma_f32_16x16x32_bf16 v[40:43], v[36:39], v[32:35], v[232:235]
    v_max_f32 v26, v26, v30
    v_max_f32 v24, v24, v28
    v_mfma_f32_16x16x16_bf16 v[156:159], v[2:3], v[246:247], v[240:243]
    v_max_f32 v58, v58, v62
    v_max_f32 v25, v25, v29
    v_mfma_f32_16x16x16_bf16 v[164:167], v[34:35], v[246:247], v[240:243]
    v_max_f32 v56, v56, v60
    v_max_f32 v57, v57, v61
    v_mfma_f32_16x16x16_bf16 v[168:171], v[50:51], v[246:247], v[240:243]
    v_max_f32 v42, v42, v46
    v_max_f32 v41, v41, v45
    v_mfma_f32_16x16x32_bf16 v[80:83], v[184:187], v[176:179], v[80:83]
    v_max_f32 v40, v40, v44
    v_max_f32 v59, v59, v63
    v_mfma_f32_16x16x32_bf16 v[64:67], v[184:187], v[172:175], v[64:67]
    v_max3_f32 v251, v56, v57, v58
    v_max3_f32 v249, v24, v25, v26
    v_mfma_f32_16x16x32_bf16 v[100:103], v[188:191], v[180:183], v[100:103]
    v_max_f32 v251, v251, v59
    v_max_f32 v43, v43, v47
    v_mfma_f32_16x16x32_bf16 v[76:79], v[196:199], v[172:175], v[76:79]
    v_max3_f32 v250, v40, v41, v42
    v_max3_f32 v248, v8, v9, v10
    v_mfma_f32_16x16x32_bf16 v[96:99], v[184:187], v[180:183], v[96:99]
    v_max_f32 v248, v248, v11
    v_max_f32 v250, v250, v43
    v_mfma_f32_16x16x32_bf16 v[68:71], v[188:191], v[172:175], v[68:71]
    v_max_f32 v27, v27, v31
    v_max_f32 v249, v249, v27
    v_mfma_f32_16x16x32_bf16 v[108:111], v[196:199], v[180:183], v[108:111]
    v_permlane32_swap_b32_e64 v250, v251
    v_mfma_f32_16x16x32_bf16 v[92:95], v[196:199], v[176:179], v[92:95]
    v_permlane32_swap_b32_e64 v248, v249
    v_mfma_f32_16x16x32_bf16 v[104:107], v[136:139], v[148:151], v[104:107]
    v_max_f32 v250, v250, v251
    v_max_f32 v248, v248, v249
    v_mfma_f32_16x16x32_bf16 v[88:91], v[176:179], v[192:195], v[88:91]
    v_cvt_pk_bf16_f32 v129, v158, v159
    v_permlane16_swap_b32_e64 v248, v250
    v_mfma_f32_16x16x32_bf16 v[104:107], v[180:183], v[192:195], v[104:107]
    v_max_f32 v249, v248, v250
    v_mul_f32 v248, s60, v249
    v_mfma_f32_16x16x32_bf16 v[72:75], v[172:175], v[192:195], v[72:75]
    v_mul_f32_e64 v250, s60, v249
    v_cvt_pk_bf16_f32 v128, v156, v157
    v_cvt_pk_bf16_f32 v132, v164, v165
    v_permlane16_swap_b32 v248, v250
    v_mov_b32 v249, v248
    v_mov_b32_e64 v251, v250
    v_cvt_pk_bf16_f32 v133, v166, v167
    v_permlane32_swap_b32_e64 v248, v249
    v_pk_fma_f32 v[8:9], v[8:9], s[60:61], v[248:249] op_sel:[0,0,0] op_sel_hi:[1,0,0] neg_lo:[0,0,1] neg_hi:[0,0,1]
    v_pk_fma_f32 v[10:11], v[10:11], s[60:61], v[248:249] op_sel:[0,0,0] op_sel_hi:[1,0,0] neg_lo:[0,0,1] neg_hi:[0,0,1]
    v_pk_fma_f32 v[24:25], v[24:25], s[60:61], v[248:249] op_sel:[0,0,1] op_sel_hi:[1,0,1] neg_lo:[0,0,1] neg_hi:[0,0,1]
    v_pk_fma_f32 v[26:27], v[26:27], s[60:61], v[248:249] op_sel:[0,0,1] op_sel_hi:[1,0,1] neg_lo:[0,0,1] neg_hi:[0,0,1]
    v_exp_f32 v8, v8
    v_exp_f32 v10, v10
    v_exp_f32 v9, v9
    v_exp_f32 v11, v11
    v_exp_f32_e64 v27, v27
    v_cvt_pk_bf16_f32 v13, v10, v11
    v_cvt_pk_bf16_f32 v12, v8, v9
    v_exp_f32 v26, v26
    v_exp_f32 v25, v25
    v_mfma_f32_16x16x16_bf16 v[156:159], v[128:129], v[12:13], 0
    v_exp_f32_e64 v24, v24
    v_mfma_f32_16x16x16_bf16 v[0:3], v[112:113], v[12:13], 0
    v_cvt_pk_bf16_f32 v28, v24, v25
    v_cvt_pk_bf16_f32 v29, v26, v27
    v_and_b32 v31, v29, v245
    v_and_b32 v30, v28, v244
    v_xor_b32 v28, v28, v30
    v_xor_b32 v29, v29, v31
    v_rcp_f32 v158, v157
    v_permlane32_swap_b32 v250, v251
    v_pk_mul_f32 v[2:3], v[2:3], v[158:159] op_sel_hi:[1,0]
    v_pk_mul_f32 v[0:1], v[0:1], v[158:159] op_sel_hi:[1,0]
    v_pk_fma_f32 v[42:43], v[42:43], s[60:61], v[250:251] op_sel:[0,0,0] op_sel_hi:[1,0,0] neg_lo:[0,0,1] neg_hi:[0,0,1]
    v_pk_fma_f32 v[40:41], v[40:41], s[60:61], v[250:251] op_sel:[0,0,0] op_sel_hi:[1,0,0] neg_lo:[0,0,1] neg_hi:[0,0,1]
    v_pk_fma_f32 v[58:59], v[58:59], s[60:61], v[250:251] op_sel:[0,0,1] op_sel_hi:[1,0,1] neg_lo:[0,0,1] neg_hi:[0,0,1]
    v_pk_fma_f32 v[56:57], v[56:57], s[60:61], v[250:251] op_sel:[0,0,1] op_sel_hi:[1,0,1] neg_lo:[0,0,1] neg_hi:[0,0,1]
    v_mfma_f32_16x16x32_bf16 v[160:163], v[128:131], v[28:31], 0
    v_exp_f32_e64 v40, v40
    v_mfma_f32_16x16x32_bf16 v[16:19], v[112:115], v[28:31], 0
    v_cvt_pk_bf16_f32 v8, v0, v1
    v_cvt_pk_bf16_f32 v9, v2, v3
    v_exp_f32 v42, v42
    v_exp_f32 v43, v43
    v_exp_f32_e64 v41, v41
    v_cvt_pk_bf16_f32 v45, v42, v43
    v_rcp_f32 v162, v161
    v_and_b32 v47, v45, v245
    v_pk_mul_f32 v[16:17], v[16:17], v[162:163] op_sel_hi:[1,0]
    v_pk_mul_f32 v[18:19], v[18:19], v[162:163] op_sel_hi:[1,0]
    v_cvt_pk_bf16_f32 v44, v40, v41
    v_xor_b32_e64 v45, v45, v47
    v_cvt_pk_bf16_f32 v24, v16, v17
    v_and_b32 v46, v44, v244
    v_exp_f32 v59, v59
    v_exp_f32 v57, v57
    v_xor_b32 v44, v44, v46
    v_cvt_pk_bf16_f32 v25, v18, v19
    v_exp_f32_e64 v58, v58
    v_mfma_f32_16x16x32_bf16 v[164:167], v[130:133], v[44:47], 0
    v_exp_f32_e64 v56, v56
    v_mfma_f32_16x16x32_bf16 v[32:35], v[114:117], v[44:47], 0
    v_cvt_pk_bf16_f32 v60, v56, v57
    v_cvt_pk_bf16_f32 v61, v58, v59
    v_and_b32_e64 v62, v60, v244
    v_cvt_pk_bf16_f32 v134, v168, v169
    v_cvt_pk_bf16_f32 v135, v170, v171
    v_and_b32 v63, v61, v245
    v_xor_b32 v60, v60, v62
    v_mul_f32 v160, v160, v162
    v_mul_f32 v156, v156, v158
    v_cvt_pk_bf16_f32 v26, v156, v160
    v_xor_b32 v61, v61, v63
    v_rcp_f32 v166, v165
    v_cvt_pk_bf16_f32 v80, v80, v81
    v_pk_mul_f32 v[34:35], v[34:35], v[166:167] op_sel_hi:[1,0]
    v_pk_mul_f32 v[32:33], v[32:33], v[166:167] op_sel_hi:[1,0]
    v_mfma_f32_16x16x32_bf16 v[168:171], v[132:135], v[60:63], 0
    v_cvt_pk_bf16_f32 v41, v34, v35
    v_cvt_pk_bf16_f32 v40, v32, v33
    v_mfma_f32_16x16x32_bf16 v[48:51], v[116:119], v[60:63], 0
    v_mul_f32_e64 v164, v164, v166
    v_cvt_pk_bf16_f32 v100, v100, v101
    v_cvt_pk_bf16_f32 v64, v64, v65
    v_cvt_pk_bf16_f32 v96, v96, v97
    v_cvt_pk_bf16_f32 v68, v68, v69
    v_rcp_f32_e64 v170, v169
    v_cvt_pk_bf16_f32 v65, v66, v67
    v_mul_f32_e64 v168, v168, v170
    v_pk_mul_f32 v[48:49], v[48:49], v[170:171] op_sel_hi:[1,0]
    v_pk_mul_f32 v[50:51], v[50:51], v[170:171] op_sel_hi:[1,0]
    v_cvt_pk_bf16_f32 v56, v48, v49
    v_cvt_pk_bf16_f32 v57, v50, v51
    v_cvt_pk_bf16_f32 v58, v164, v168
    v_cvt_pk_bf16_f32 v66, v76, v77
    v_cvt_pk_bf16_f32 v85, v86, v87
    v_cvt_pk_bf16_f32 v81, v82, v83
    v_cvt_pk_bf16_f32 v83, v94, v95
    v_cvt_pk_bf16_f32 v97, v98, v99
    v_cvt_pk_bf16_f32 v98, v108, v109
    v_cvt_pk_bf16_f32 v69, v70, v71
    v_mov_b64 v[86:87], 0
    s_barrier
    v_cvt_pk_bf16_f32 v101, v102, v103
    v_mov_b64_e64 v[70:71], 0
    v_cvt_pk_bf16_f32 v67, v78, v79
    v_cvt_pk_bf16_f32 v99, v110, v111
    v_cvt_pk_bf16_f32 v82, v92, v93
    v_mov_b64 v[102:103], 0
    v_permlane32_swap_b32 v67, v71
    v_permlane32_swap_b32 v82, v86
    v_permlane32_swap_b32 v98, v102
    v_permlane32_swap_b32_e64 v66, v70
    ds_write_b64 v230, v[8:9] offset:0
    v_permlane32_swap_b32_e64 v99, v103
    ds_write_b64 v230, v[24:25] offset:2816
    v_mfma_f32_16x16x32_bf16 v[76:79], v[52:55], v[64:67], v[236:239]
    ds_write_b16 v231, v26 offset:0
    v_mfma_f32_16x16x16_bf16 v[172:175], v[66:67], v[246:247], v[240:243]
    ds_write_b16_d16_hi v231, v26 offset:2816
    v_mfma_f32_16x16x16_bf16 v[180:183], v[98:99], v[246:247], v[240:243]
    ds_write_b64 v230, v[40:41] offset:5632
    v_permlane32_swap_b32_e64 v83, v87
    ds_write_b64 v230, v[56:57] offset:8448
    v_cvt_pk_bf16_f32 v123, v90, v91
    v_mfma_f32_16x16x32_bf16 v[92:95], v[68:71], v[80:83], v[236:239]
    ds_write_b16 v231, v58 offset:5632
    v_mfma_f32_16x16x32_bf16 v[108:111], v[84:87], v[96:99], v[236:239]
    ds_write_b16_d16_hi v231, v58 offset:8448
    v_mfma_f32_16x16x16_bf16 v[176:179], v[82:83], v[246:247], v[240:243]
    v_cvt_pk_bf16_f32 v122, v88, v89
    v_cvt_pk_bf16_f32 v125, v106, v107
    v_mfma_f32_16x16x32_bf16 v[88:91], v[84:87], v[80:83], v[232:235]
    v_cvt_pk_bf16_f32 v124, v104, v105
    v_cvt_pk_bf16_f32 v120, v72, v73
    v_mfma_f32_16x16x32_bf16 v[104:107], v[100:103], v[96:99], v[232:235]
    v_cvt_pk_bf16_f32 v121, v74, v75
    v_cvt_pk_bf16_f32 v136, v172, v173
    s_waitcnt lgkmcnt(0)
    s_barrier
    v_mfma_f32_16x16x32_bf16 v[72:75], v[68:71], v[64:67], v[232:235]
    v_cvt_pk_bf16_f32 v137, v174, v175
    v_cvt_pk_bf16_f32 v138, v176, v177
    v_max_f32 v88, v88, v92
    v_max_f32 v89, v89, v93
    v_max_f32 v90, v90, v94
    v_max_f32 v105, v105, v109
    v_max_f32_e64 v106, v106, v110
    v_max3_f32 v253, v88, v89, v90
    v_max_f32 v74, v74, v78
    v_max_f32 v72, v72, v76
    v_max_f32 v75, v75, v79
    v_max_f32 v73, v73, v77
    v_max3_f32 v252, v72, v73, v74
    v_max_f32_e64 v104, v104, v108
    v_max3_f32 v254, v104, v105, v106
    v_max_f32 v91, v91, v95
    v_max_f32 v253, v253, v91
    v_max_f32 v252, v252, v75
    v_max_f32 v107, v107, v111
    v_max_f32 v254, v254, v107
    v_permlane32_swap_b32 v252, v253
    v_max_f32 v252, v252, v253
    v_permlane32_swap_b32 v254, v255
    v_max_f32_e64 v254, v254, v255
    v_cvt_pk_bf16_f32 v139, v178, v179
    v_cvt_pk_bf16_f32 v141, v182, v183
    v_permlane16_swap_b32 v252, v254
    v_max_f32 v253, v252, v254
    v_mul_f32 v254, s60, v253
    v_mul_f32 v252, s60, v253
    v_cvt_pk_bf16_f32 v140, v180, v181
    s_nop 0
    v_permlane16_swap_b32 v252, v254
    v_mov_b32 v253, v252
    v_mov_b32 v255, v254
    s_nop 0
    v_permlane32_swap_b32 v252, v253
    v_pk_fma_f32 v[74:75], v[74:75], s[60:61], v[252:253] op_sel:[0,0,0] op_sel_hi:[1,0,0] neg_lo:[0,0,1] neg_hi:[0,0,1]
    v_pk_fma_f32 v[72:73], v[72:73], s[60:61], v[252:253] op_sel:[0,0,0] op_sel_hi:[1,0,0] neg_lo:[0,0,1] neg_hi:[0,0,1]
    v_pk_fma_f32 v[90:91], v[90:91], s[60:61], v[252:253] op_sel:[0,0,1] op_sel_hi:[1,0,1] neg_lo:[0,0,1] neg_hi:[0,0,1]
    v_pk_fma_f32 v[88:89], v[88:89], s[60:61], v[252:253] op_sel:[0,0,1] op_sel_hi:[1,0,1] neg_lo:[0,0,1] neg_hi:[0,0,1]
    v_exp_f32 v72, v72
    v_exp_f32 v74, v74
    v_exp_f32 v73, v73
    v_exp_f32 v75, v75
    v_cvt_pk_bf16_f32 v76, v72, v73
    v_cvt_pk_bf16_f32 v77, v74, v75
    v_and_b32 v79, v77, v245
    v_and_b32 v78, v76, v244
    v_exp_f32 v91, v91
    v_xor_b32 v76, v76, v78
    v_exp_f32 v90, v90
    v_xor_b32 v77, v77, v79
    v_exp_f32 v89, v89
    v_exp_f32 v88, v88
    v_mfma_f32_16x16x32_bf16 v[172:175], v[134:137], v[76:79], 0
    v_cvt_pk_bf16_f32 v93, v90, v91
    v_and_b32_e64 v95, v93, v245
    v_mfma_f32_16x16x32_bf16 v[64:67], v[118:121], v[76:79], 0
    v_xor_b32_e64 v93, v93, v95
    v_cvt_pk_bf16_f32 v92, v88, v89
    v_and_b32 v94, v92, v244
    v_xor_b32 v92, v92, v94
    v_permlane32_swap_b32_e64 v254, v255
    v_pk_fma_f32 v[106:107], v[106:107], s[60:61], v[254:255] op_sel:[0,0,0] op_sel_hi:[1,0,0] neg_lo:[0,0,1] neg_hi:[0,0,1]
    v_pk_fma_f32 v[104:105], v[104:105], s[60:61], v[254:255] op_sel:[0,0,0] op_sel_hi:[1,0,0] neg_lo:[0,0,1] neg_hi:[0,0,1]
    v_mfma_f32_16x16x32_bf16 v[176:179], v[136:139], v[92:95], 0
    v_rcp_f32_e64 v174, v173
    v_mfma_f32_16x16x32_bf16 v[80:83], v[120:123], v[92:95], 0
    v_exp_f32 v105, v105
    v_exp_f32 v104, v104
    v_exp_f32_e64 v106, v106
    v_pk_mul_f32 v[64:65], v[64:65], v[174:175] op_sel_hi:[1,0]
    v_pk_mul_f32 v[66:67], v[66:67], v[174:175] op_sel_hi:[1,0]
    v_cvt_pk_bf16_f32 v73, v66, v67
    v_cvt_pk_bf16_f32 v72, v64, v65
    ds_write_b64 v230, v[72:73] offset:11264
    v_rcp_f32 v178, v177
    v_exp_f32 v107, v107
    v_pk_mul_f32 v[80:81], v[80:81], v[178:179] op_sel_hi:[1,0]
    v_pk_mul_f32 v[82:83], v[82:83], v[178:179] op_sel_hi:[1,0]
    v_cvt_pk_bf16_f32 v108, v104, v105
    v_cvt_pk_bf16_f32 v109, v106, v107
    v_and_b32 v111, v109, v245
    v_xor_b32 v109, v109, v111
    v_and_b32 v110, v108, v244
    v_xor_b32 v108, v108, v110
    v_cvt_pk_bf16_f32 v88, v80, v81
    v_cvt_pk_bf16_f32 v89, v82, v83
    v_mfma_f32_16x16x32_bf16 v[180:183], v[138:141], v[108:111], 0
    ds_write_b64 v230, v[88:89] offset:14080
    v_mfma_f32_16x16x32_bf16 v[96:99], v[122:125], v[108:111], 0
    v_mul_f32 v172, v172, v174
    v_mul_f32 v176, v176, v178
    v_cvt_pk_bf16_f32 v90, v172, v176
    ds_write_b16 v231, v90 offset:11264
    ds_write_b16_d16_hi v231, v90 offset:14080
    s_nop 0
    v_rcp_f32_e64 v182, v181
    s_nop 0
    v_pk_mul_f32 v[96:97], v[96:97], v[182:183] op_sel_hi:[1,0]
    v_pk_mul_f32 v[98:99], v[98:99], v[182:183] op_sel_hi:[1,0]
    v_cvt_pk_bf16_f32 v105, v98, v99
    v_cvt_pk_bf16_f32 v104, v96, v97
    ds_write_b64 v230, v[104:105] offset:16896
    v_mul_f32_e64 v180, v180, v182
    v_cvt_pk_bf16_f32 v106, v180, v180
    ds_write_b16 v231, v106 offset:16896
    s_waitcnt lgkmcnt(0)

    s_barrier
L_p2q:
L_p2:
    v_mbcnt_lo_u32_b32 v250, -1, 0
    v_mbcnt_hi_u32_b32 v250, -1, v250
    v_and_b32 v1, 15, v250
    v_lshrrev_b32 v7, 4, v250
    v_mul_u32_u24 v0, 6554, v250
    v_lshlrev_b32 v250, 4, v250
    v_lshrrev_b32 v0, 16, v0
    v_mul_u32_u24 v0, 81760, v0
    v_add_u32 v254, v0, v250
    v_add_u32 v252, 61440, v250
    v_lshlrev_b32 v6, 6, v1
    v_add_u32 v6, s98, v6
    v_lshl_add_u32 v253, v1, 2, s42
    v_lshrrev_b32 v0, 1, v1
    v_xor_b32 v0, v0, v7
    v_lshlrev_b32 v0, 4, v0
    v_lshl_add_u32 v0, v1, 7, v0
    v_add_u32 v248, s99, v0
    v_xor_b32 v249, 64, v248
    v_mul_u32_u24 v0, 1280, v7
    v_lshl_add_u32 v0, v1, 4, v0
    v_add_u32 v251, 143360, v0
    v_lshlrev_b32 v7, 1, v7
    v_add_u32 v0, 0, v7
    v_mul_u32_u24 v0, v0, v6
    v_and_b32 v0, 2047, v0
    v_cvt_f32_u32 v0, v0
    v_mul_f32 v0, 0x3a000000, v0
    v_cos_f32 v4, v0
    v_sin_f32 v5, v0
    v_mul_f32 v0, s64, v4
    v_mul_f32 v1, s66, v4
    v_mul_f32 v3, s68, v4
    v_fmac_f32 v1, s65, v5
    v_mul_f32 v2, s67, v5
    v_fmac_f32 v3, s69, v5
    v_cvt_pk_bf16_f32 v20, v0, v1
    v_cvt_pk_bf16_f32 v21, v2, v3
    v_add_u32 v0, 1, v7
    v_mul_u32_u24 v0, v0, v6
    v_and_b32 v0, 2047, v0
    v_cvt_f32_u32 v0, v0
    v_mul_f32 v0, 0x3a000000, v0
    v_cos_f32 v4, v0
    v_sin_f32 v5, v0
    v_mul_f32 v0, s64, v4
    v_mul_f32 v1, s66, v4
    v_mul_f32 v3, s68, v4
    v_fmac_f32 v1, s65, v5
    v_mul_f32 v2, s67, v5
    v_fmac_f32 v3, s69, v5
    v_cvt_pk_bf16_f32 v22, v0, v1
    v_cvt_pk_bf16_f32 v23, v2, v3
    v_add_u32 v0, 8, v7
    v_mul_u32_u24 v0, v0, v6
    v_and_b32 v0, 2047, v0
    v_cvt_f32_u32 v0, v0
    v_mul_f32 v0, 0x3a000000, v0
    v_cos_f32 v4, v0
    v_sin_f32 v5, v0
    v_mul_f32 v0, s64, v4
    v_mul_f32 v1, s66, v4
    v_mul_f32 v3, s68, v4
    v_fmac_f32 v1, s65, v5
    v_mul_f32 v2, s67, v5
    v_fmac_f32 v3, s69, v5
    v_cvt_pk_bf16_f32 v24, v0, v1
    v_cvt_pk_bf16_f32 v25, v2, v3
    v_add_u32 v0, 9, v7
    v_mul_u32_u24 v0, v0, v6
    v_and_b32 v0, 2047, v0
    v_cvt_f32_u32 v0, v0
    v_mul_f32 v0, 0x3a000000, v0
    v_cos_f32 v4, v0
    v_sin_f32 v5, v0
    v_mul_f32 v0, s64, v4
    v_mul_f32 v1, s66, v4
    v_mul_f32 v3, s68, v4
    v_fmac_f32 v1, s65, v5
    v_mul_f32 v2, s67, v5
    v_fmac_f32 v3, s69, v5
    v_cvt_pk_bf16_f32 v26, v0, v1
    v_cvt_pk_bf16_f32 v27, v2, v3
    v_add_u32 v0, 16, v7
    v_mul_u32_u24 v0, v0, v6
    v_and_b32 v0, 2047, v0
    v_cvt_f32_u32 v0, v0
    v_mul_f32 v0, 0x3a000000, v0
    v_cos_f32 v4, v0
    v_sin_f32 v5, v0
    v_mul_f32 v0, s64, v4
    v_mul_f32 v1, s66, v4
    v_mul_f32 v3, s68, v4
    v_fmac_f32 v1, s65, v5
    v_mul_f32 v2, s67, v5
    v_fmac_f32 v3, s69, v5
    v_cvt_pk_bf16_f32 v28, v0, v1
    v_cvt_pk_bf16_f32 v29, v2, v3
    v_add_u32 v0, 17, v7
    v_mul_u32_u24 v0, v0, v6
    v_and_b32 v0, 2047, v0
    v_cvt_f32_u32 v0, v0
    v_mul_f32 v0, 0x3a000000, v0
    v_cos_f32 v4, v0
    v_sin_f32 v5, v0
    v_mul_f32 v0, s64, v4
    v_mul_f32 v1, s66, v4
    v_mul_f32 v3, s68, v4
    v_fmac_f32 v1, s65, v5
    v_mul_f32 v2, s67, v5
    v_fmac_f32 v3, s69, v5
    v_cvt_pk_bf16_f32 v30, v0, v1
    v_cvt_pk_bf16_f32 v31, v2, v3
L_pg:
    v_and_b32 v40, 0xf0, v250
    v_lshrrev_b32 v41, 8, v250
    v_mul_u32_u24 v40, 11, v40
    v_mul_u32_u24 v42, 6554, v250
    v_lshl_add_u32 v40, v41, 3, v40
    v_lshrrev_b32 v42, 20, v42
    v_add_u32 v36, s99, v40
    v_lshl_add_u32 v42, v42, 4, v250
    v_add_u32 v37, s99, v42
    s_mov_b32 s59, 2000
    s_barrier
    ds_read_b128 v[88:91], v252 offset:0
    ds_read_b128 v[92:95], v252 offset:1024
    v_add_u32 v0, 24, v7
    ds_read_b128 v[96:99], v252 offset:2048
    ds_read_b128 v[100:103], v252 offset:3072
    v_mul_u32_u24 v0, v0, v6
    ds_read_b128 v[104:107], v252 offset:4096
    v_and_b32 v0, 2047, v0
    ds_read_b128 v[108:111], v252 offset:5120
    ds_read_b128 v[112:115], v252 offset:6144
    v_cvt_f32_u32 v0, v0
    ds_read_b128 v[116:119], v252 offset:7168
    v_mul_f32 v0, 0x3a000000, v0
    ds_read_b128 v[120:123], v252 offset:8192
    ds_read_b128 v[124:127], v252 offset:9216
    v_cos_f32 v4, v0
    ds_read_b128 v[128:131], v252 offset:10240
    v_sin_f32 v5, v0
    ds_read_b128 v[132:135], v252 offset:11264
    ds_read_b128 v[136:139], v252 offset:12288
    v_mul_f32 v0, s64, v4
    ds_read_b128 v[140:143], v252 offset:13312
    v_mul_f32 v1, s66, v4
    ds_read_b128 v[144:147], v252 offset:14336
    ds_read_b128 v[148:151], v252 offset:15360
    v_mul_f32 v3, s68, v4
    ds_read_b128 v[152:155], v252 offset:16384
    v_fmac_f32 v1, s65, v5
    ds_read_b128 v[156:159], v252 offset:17408
    ds_read_b128 v[160:163], v252 offset:18432
    v_mul_f32 v2, s67, v5
    ds_read_b128 v[164:167], v252 offset:19456
    v_fmac_f32 v3, s69, v5
    ds_read_b128 v[168:171], v252 offset:20480
    ds_read_b128 v[172:175], v252 offset:21504
    v_cvt_pk_bf16_f32 v32, v0, v1
    ds_read_b128 v[176:179], v252 offset:22528
    v_cvt_pk_bf16_f32 v33, v2, v3
    ds_read_b128 v[180:183], v252 offset:23552
    ds_read_b128 v[184:187], v252 offset:24576
    v_add_u32 v0, 25, v7
    ds_read_b128 v[188:191], v252 offset:25600
    ds_read_b128 v[192:195], v252 offset:26624
    v_mul_u32_u24 v0, v0, v6
    ds_read_b128 v[196:199], v252 offset:27648
    v_and_b32 v0, 2047, v0
    ds_read_b128 v[200:203], v252 offset:28672
    ds_read_b128 v[204:207], v252 offset:29696
    v_cvt_f32_u32 v0, v0
    ds_read_b128 v[208:211], v252 offset:30720
    v_mul_f32 v0, 0x3a000000, v0
    ds_read_b128 v[212:215], v252 offset:31744
    ds_read_b128 v[216:219], v252 offset:32768
    v_cos_f32 v4, v0
    ds_read_b128 v[220:223], v252 offset:33792
    v_sin_f32 v5, v0
    ds_read_b128 v[224:227], v252 offset:34816
    ds_read_b128 v[228:231], v252 offset:35840
    v_mul_f32 v0, s64, v4
    ds_read_b128 v[232:235], v252 offset:36864
    v_mul_f32 v1, s66, v4
    ds_read_b128 v[236:239], v252 offset:37888
    ds_read_b128 v[240:243], v252 offset:38912
    v_mul_f32 v3, s68, v4
    ds_read_b128 v[244:247], v252 offset:39936
    v_fmac_f32 v1, s65, v5
    ds_read_b128 v[40:43], v250 offset:0
    ds_read_b128 v[44:47], v250 offset:1024
    v_mul_f32 v2, s67, v5
    ds_read_b128 v[48:51], v250 offset:2048
    v_fmac_f32 v3, s69, v5
    ds_read_b128 v[52:55], v250 offset:3072
    ds_read_b128 v[56:59], v250 offset:4096
    v_cvt_pk_bf16_f32 v34, v0, v1
    ds_read_b128 v[60:63], v250 offset:5120
    v_cvt_pk_bf16_f32 v35, v2, v3
    s_waitcnt lgkmcnt(6)
    s_barrier
    ds_read_b128 v[76:79], v248 offset:0
    ds_read_b128 v[80:83], v249 offset:0
    s_waitcnt lgkmcnt(0)
    v_max3_u32 v255, v76, v79, v80
    v_max_u32 v255, v255, v83
    v_cmp_eq_u32 vcc, -1, v255
    s_barrier
    s_cbranch_vccnz L_fix0
L_go0:
.p2align 3
    v_mfma_f32_16x16x32_bf16 v[0:3], v[88:91], v[76:79], 0
    ds_read_b128 v[84:87], v248 offset:2048
    ds_read_b128 v[64:67], v250 offset:6144
    v_mfma_f32_16x16x32_bf16 v[4:7], v[92:95], v[76:79], 0
    ds_read_b128 v[88:91], v249 offset:2048
    v_mfma_f32_16x16x32_bf16 v[8:11], v[40:43], v[76:79], 0
    ds_read_b128 v[68:71], v250 offset:7168
    v_mfma_f32_16x16x32_bf16 v[12:15], v[44:47], v[76:79], 0
    ds_read_b128 v[72:75], v250 offset:8192
    v_mfma_f32_16x16x32_bf16 v[16:19], v[48:51], v[76:79], 0
    ds_read_b128 v[40:43], v250 offset:9216
    v_mfma_f32_16x16x32_bf16 v[0:3], v[96:99], v[80:83], v[0:3]
    ds_read_b128 v[44:47], v250 offset:10240
    ds_read_b128 v[48:51], v250 offset:11264
    v_mfma_f32_16x16x32_bf16 v[4:7], v[100:103], v[80:83], v[4:7]
    s_waitcnt lgkmcnt(5)
    v_max3_u32 v255, v84, v87, v88
    v_mfma_f32_16x16x32_bf16 v[8:11], v[52:55], v[80:83], v[8:11]
    v_max_u32 v255, v255, v91
    v_cmp_eq_u32_e64 vcc, -1, v255
    v_mfma_f32_16x16x32_bf16 v[12:15], v[56:59], v[80:83], v[12:15]
    s_barrier
    v_mfma_f32_16x16x32_bf16 v[16:19], v[60:63], v[80:83], v[16:19]
    s_cbranch_vccnz L_fix1
L_go1:
    v_mfma_f32_16x16x32_bf16 v[0:3], v[104:107], v[84:87], v[0:3]
    ds_read_b128 v[96:99], v248 offset:4096
    ds_read_b128 v[100:103], v249 offset:4096
    v_mfma_f32_16x16x32_bf16 v[4:7], v[108:111], v[84:87], v[4:7]
    ds_read_b128 v[52:55], v250 offset:12288
    s_waitcnt lgkmcnt(6)
    v_mfma_f32_16x16x32_bf16 v[8:11], v[64:67], v[84:87], v[8:11]
    ds_read_b128 v[56:59], v250 offset:13312
    v_mfma_f32_16x16x32_bf16 v[12:15], v[68:71], v[84:87], v[12:15]
    ds_read_b128 v[60:63], v250 offset:14336
    v_mfma_f32_16x16x32_bf16 v[16:19], v[72:75], v[84:87], v[16:19]
    ds_read_b128 v[64:67], v250 offset:15360
    v_mfma_f32_16x16x32_bf16 v[0:3], v[112:115], v[88:91], v[0:3]
    ds_read_b128 v[68:71], v250 offset:16384
    ds_read_b128 v[72:75], v250 offset:17408
    v_mfma_f32_16x16x32_bf16 v[4:7], v[116:119], v[88:91], v[4:7]
    s_waitcnt lgkmcnt(6)
    v_max3_u32 v255, v96, v99, v100
    v_mfma_f32_16x16x32_bf16 v[8:11], v[40:43], v[88:91], v[8:11]
    v_max_u32 v255, v255, v103
    v_cmp_eq_u32 vcc, -1, v255
    v_mfma_f32_16x16x32_bf16 v[12:15], v[44:47], v[88:91], v[12:15]
    s_barrier
    v_mfma_f32_16x16x32_bf16 v[16:19], v[48:51], v[88:91], v[16:19]
    s_cbranch_vccnz L_fix2
L_go2:
    v_mfma_f32_16x16x32_bf16 v[0:3], v[120:123], v[96:99], v[0:3]
    ds_read_b128 v[112:115], v248 offset:6144
    ds_read_b128 v[116:119], v249 offset:6144
    v_mfma_f32_16x16x32_bf16 v[4:7], v[124:127], v[96:99], v[4:7]
    ds_read_b128 v[40:43], v250 offset:18432
    s_waitcnt lgkmcnt(6)
    v_mfma_f32_16x16x32_bf16 v[8:11], v[52:55], v[96:99], v[8:11]
    ds_read_b128 v[44:47], v250 offset:19456
    v_mfma_f32_16x16x32_bf16 v[12:15], v[56:59], v[96:99], v[12:15]
    ds_read_b128 v[48:51], v250 offset:20480
    v_mfma_f32_16x16x32_bf16 v[16:19], v[60:63], v[96:99], v[16:19]
    ds_read_b128 v[52:55], v250 offset:21504
    v_mfma_f32_16x16x32_bf16 v[0:3], v[128:131], v[100:103], v[0:3]
    ds_read_b128 v[56:59], v250 offset:22528
    ds_read_b128 v[60:63], v250 offset:23552
    v_mfma_f32_16x16x32_bf16 v[4:7], v[132:135], v[100:103], v[4:7]
    s_waitcnt lgkmcnt(6)
    v_max3_u32 v255, v112, v115, v116
    v_mfma_f32_16x16x32_bf16 v[8:11], v[64:67], v[100:103], v[8:11]
    v_max_u32 v255, v255, v119
    v_cmp_eq_u32 vcc, -1, v255
    v_mfma_f32_16x16x32_bf16 v[12:15], v[68:71], v[100:103], v[12:15]
    s_barrier
    v_mfma_f32_16x16x32_bf16 v[16:19], v[72:75], v[100:103], v[16:19]
    s_cbranch_vccnz L_fix3
L_go3:
    v_mfma_f32_16x16x32_bf16 v[0:3], v[136:139], v[112:115], v[0:3]
    ds_read_b128 v[128:131], v248 offset:8192
    ds_read_b128 v[132:135], v249 offset:8192
    v_mfma_f32_16x16x32_bf16 v[4:7], v[140:143], v[112:115], v[4:7]
    ds_read_b128 v[64:67], v250 offset:24576
    s_waitcnt lgkmcnt(6)
    v_mfma_f32_16x16x32_bf16 v[8:11], v[40:43], v[112:115], v[8:11]
    ds_read_b128 v[68:71], v250 offset:25600
    v_mfma_f32_16x16x32_bf16 v[12:15], v[44:47], v[112:115], v[12:15]
    ds_read_b128 v[72:75], v250 offset:26624
    v_subrev_u32 v248, 40960, v248
    v_subrev_u32 v249, 40960, v249
    v_mfma_f32_16x16x32_bf16 v[16:19], v[48:51], v[112:115], v[16:19]
    ds_read_b128 v[40:43], v250 offset:27648
    v_mfma_f32_16x16x32_bf16 v[0:3], v[144:147], v[116:119], v[0:3]
    ds_read_b128 v[44:47], v250 offset:28672
    ds_read_b128 v[48:51], v250 offset:29696
    v_mfma_f32_16x16x32_bf16 v[4:7], v[148:151], v[116:119], v[4:7]
    s_waitcnt lgkmcnt(6)
    v_max3_u32 v255, v128, v131, v132
    v_mfma_f32_16x16x32_bf16 v[8:11], v[52:55], v[116:119], v[8:11]
    v_max_u32 v255, v255, v135
    v_cmp_eq_u32 vcc, -1, v255
    v_mfma_f32_16x16x32_bf16 v[12:15], v[56:59], v[116:119], v[12:15]
    s_barrier
    v_mfma_f32_16x16x32_bf16 v[16:19], v[60:63], v[116:119], v[16:19]
    s_cbranch_vccnz L_fix4
L_go4:
    v_mfma_f32_16x16x32_bf16 v[0:3], v[152:155], v[128:131], v[0:3]
    ds_read_b128 v[144:147], v248 offset:0
    ds_read_b128 v[148:151], v249 offset:0
    v_mfma_f32_16x16x32_bf16 v[4:7], v[156:159], v[128:131], v[4:7]
    ds_read_b128 v[52:55], v250 offset:30720
    s_waitcnt lgkmcnt(6)
    v_mfma_f32_16x16x32_bf16 v[8:11], v[64:67], v[128:131], v[8:11]
    ds_read_b128 v[56:59], v250 offset:31744
    v_mfma_f32_16x16x32_bf16 v[12:15], v[68:71], v[128:131], v[12:15]
    ds_read_b128 v[60:63], v250 offset:32768
    v_mfma_f32_16x16x32_bf16 v[16:19], v[72:75], v[128:131], v[16:19]
    ds_read_b128 v[64:67], v250 offset:33792
    v_mfma_f32_16x16x32_bf16 v[0:3], v[160:163], v[132:135], v[0:3]
    ds_read_b128 v[68:71], v250 offset:34816
    ds_read_b128 v[72:75], v250 offset:35840
    v_mfma_f32_16x16x32_bf16 v[4:7], v[164:167], v[132:135], v[4:7]
    s_waitcnt lgkmcnt(6)
    v_max3_u32 v255, v144, v147, v148
    v_mfma_f32_16x16x32_bf16 v[8:11], v[40:43], v[132:135], v[8:11]
    v_max_u32 v255, v255, v151
    v_cmp_eq_u32 vcc, -1, v255
    v_mfma_f32_16x16x32_bf16 v[12:15], v[44:47], v[132:135], v[12:15]
    s_barrier
    v_mfma_f32_16x16x32_bf16 v[16:19], v[48:51], v[132:135], v[16:19]
    s_cbranch_vccnz L_fix5
L_go5:
    v_mfma_f32_16x16x32_bf16 v[0:3], v[168:171], v[144:147], v[0:3]
    ds_read_b128 v[160:163], v248 offset:2048
    ds_read_b128 v[164:167], v249 offset:2048
    v_mfma_f32_16x16x32_bf16 v[4:7], v[172:175], v[144:147], v[4:7]
    ds_read_b128 v[40:43], v250 offset:36864
    s_waitcnt lgkmcnt(6)
    v_mfma_f32_16x16x32_bf16 v[8:11], v[52:55], v[144:147], v[8:11]
    ds_read_b128 v[44:47], v250 offset:37888
    v_mfma_f32_16x16x32_bf16 v[12:15], v[56:59], v[144:147], v[12:15]
    ds_read_b128 v[48:51], v250 offset:38912
    v_mfma_f32_16x16x32_bf16 v[16:19], v[60:63], v[144:147], v[16:19]
    ds_read_b128 v[52:55], v250 offset:39936
    v_mfma_f32_16x16x32_bf16 v[0:3], v[176:179], v[148:151], v[0:3]
    ds_read_b128 v[56:59], v250 offset:40960
    ds_read_b128 v[60:63], v250 offset:41984
    v_mfma_f32_16x16x32_bf16 v[4:7], v[180:183], v[148:151], v[4:7]
    s_waitcnt lgkmcnt(6)
    v_max3_u32 v255, v160, v163, v164
    v_mfma_f32_16x16x32_bf16 v[8:11], v[64:67], v[148:151], v[8:11]
    v_max_u32 v255, v255, v167
    v_cmp_eq_u32 vcc, -1, v255
    v_mfma_f32_16x16x32_bf16 v[12:15], v[68:71], v[148:151], v[12:15]
    s_barrier
    v_mfma_f32_16x16x32_bf16 v[16:19], v[72:75], v[148:151], v[16:19]
    s_cbranch_vccnz L_fix6
L_go6:
    v_mfma_f32_16x16x32_bf16 v[0:3], v[184:187], v[160:163], v[0:3]
    ds_read_b128 v[176:179], v248 offset:4096
    ds_read_b128 v[180:183], v249 offset:4096
    v_mfma_f32_16x16x32_bf16 v[4:7], v[188:191], v[160:163], v[4:7]
    ds_read_b128 v[64:67], v250 offset:43008
    s_waitcnt lgkmcnt(6)
    v_mfma_f32_16x16x32_bf16 v[8:11], v[40:43], v[160:163], v[8:11]
    ds_read_b128 v[68:71], v250 offset:44032
    v_mfma_f32_16x16x32_bf16 v[12:15], v[44:47], v[160:163], v[12:15]
    ds_read_b128 v[72:75], v250 offset:45056
    v_mfma_f32_16x16x32_bf16 v[16:19], v[48:51], v[160:163], v[16:19]
    ds_read_b128 v[40:43], v250 offset:46080
    v_mfma_f32_16x16x32_bf16 v[0:3], v[192:195], v[164:167], v[0:3]
    ds_read_b128 v[44:47], v250 offset:47104
    ds_read_b128 v[48:51], v250 offset:48128
    v_mfma_f32_16x16x32_bf16 v[4:7], v[196:199], v[164:167], v[4:7]
    s_waitcnt lgkmcnt(6)
    v_max3_u32 v255, v176, v179, v180
    v_mfma_f32_16x16x32_bf16 v[8:11], v[52:55], v[164:167], v[8:11]
    v_max_u32 v255, v255, v183
    v_cmp_eq_u32 vcc, -1, v255
    v_mfma_f32_16x16x32_bf16 v[12:15], v[56:59], v[164:167], v[12:15]
    s_barrier
    v_mfma_f32_16x16x32_bf16 v[16:19], v[60:63], v[164:167], v[16:19]
    s_cbranch_vccnz L_fix7
L_go7:
    v_mfma_f32_16x16x32_bf16 v[0:3], v[200:203], v[176:179], v[0:3]
    ds_read_b128 v[192:195], v248 offset:6144
    ds_read_b128 v[196:199], v249 offset:6144
    v_mfma_f32_16x16x32_bf16 v[4:7], v[204:207], v[176:179], v[4:7]
    ds_read_b128 v[52:55], v250 offset:49152
    s_waitcnt lgkmcnt(6)
    v_mfma_f32_16x16x32_bf16 v[8:11], v[64:67], v[176:179], v[8:11]
    ds_read_b128 v[56:59], v250 offset:50176
    v_mfma_f32_16x16x32_bf16 v[12:15], v[68:71], v[176:179], v[12:15]
    ds_read_b128 v[60:63], v250 offset:51200
    v_mfma_f32_16x16x32_bf16 v[16:19], v[72:75], v[176:179], v[16:19]
    ds_read_b128 v[64:67], v250 offset:52224
    v_mfma_f32_16x16x32_bf16 v[0:3], v[208:211], v[180:183], v[0:3]
    ds_read_b128 v[68:71], v250 offset:53248
    ds_read_b128 v[72:75], v250 offset:54272
    v_mfma_f32_16x16x32_bf16 v[4:7], v[212:215], v[180:183], v[4:7]
    s_waitcnt lgkmcnt(6)
    v_max3_u32 v255, v192, v195, v196
    v_mfma_f32_16x16x32_bf16 v[8:11], v[40:43], v[180:183], v[8:11]
    v_max_u32 v255, v255, v199
    v_cmp_eq_u32 vcc, -1, v255
    v_mfma_f32_16x16x32_bf16 v[12:15], v[44:47], v[180:183], v[12:15]
    s_barrier
    v_mfma_f32_16x16x32_bf16 v[16:19], v[48:51], v[180:183], v[16:19]
    s_cbranch_vccnz L_fix8
L_go8:
    v_mfma_f32_16x16x32_bf16 v[0:3], v[216:219], v[192:195], v[0:3]
    ds_read_b128 v[208:211], v248 offset:8192
    ds_read_b128 v[212:215], v249 offset:8192
    v_mfma_f32_16x16x32_bf16 v[4:7], v[220:223], v[192:195], v[4:7]
    ds_read_b128 v[40:43], v250 offset:55296
    s_waitcnt lgkmcnt(6)
    v_mfma_f32_16x16x32_bf16 v[8:11], v[52:55], v[192:195], v[8:11]
    ds_read_b128 v[44:47], v250 offset:56320
    v_mfma_f32_16x16x32_bf16 v[12:15], v[56:59], v[192:195], v[12:15]
    ds_read_b128 v[48:51], v250 offset:57344
    v_mfma_f32_16x16x32_bf16 v[16:19], v[60:63], v[192:195], v[16:19]
    ds_read_b128 v[52:55], v250 offset:58368
    v_mfma_f32_16x16x32_bf16 v[0:3], v[224:227], v[196:199], v[0:3]
    ds_read_b128 v[56:59], v250 offset:59392
    ds_read_b128 v[60:63], v250 offset:60416
    v_mfma_f32_16x16x32_bf16 v[4:7], v[228:231], v[196:199], v[4:7]
    s_waitcnt lgkmcnt(6)
    v_max3_u32 v255, v208, v211, v212
    v_mfma_f32_16x16x32_bf16 v[8:11], v[64:67], v[196:199], v[8:11]
    v_max_u32 v255, v255, v215
    v_cmp_eq_u32 vcc, -1, v255
    v_mfma_f32_16x16x32_bf16 v[12:15], v[68:71], v[196:199], v[12:15]
    v_mfma_f32_16x16x32_bf16 v[16:19], v[72:75], v[196:199], v[16:19]
    s_cbranch_vccnz L_fix9
L_go9:
    s_barrier
    v_mfma_f32_16x16x32_bf16 v[0:3], v[232:235], v[208:211], v[0:3]
    ds_read_b32 v253, v253
    ds_read_b128 v[88:91], v251 offset:0
    v_mfma_f32_16x16x32_bf16 v[4:7], v[236:239], v[208:211], v[4:7]
    ds_read_b128 v[92:95], v251 offset:256
    s_waitcnt lgkmcnt(6)
    v_mfma_f32_16x16x32_bf16 v[8:11], v[40:43], v[208:211], v[8:11]
    ds_read_b128 v[96:99], v251 offset:512
    v_mfma_f32_16x16x32_bf16 v[12:15], v[44:47], v[208:211], v[12:15]
    ds_read_b128 v[100:103], v251 offset:768
    v_mfma_f32_16x16x32_bf16 v[16:19], v[48:51], v[208:211], v[16:19]
    ds_read_b128 v[104:107], v251 offset:1024
    s_barrier
    v_mfma_f32_16x16x32_bf16 v[0:3], v[240:243], v[212:215], v[0:3]
    ds_read_b128 v[108:111], v251 offset:5120
    v_mfma_f32_16x16x32_bf16 v[4:7], v[244:247], v[212:215], v[4:7]
    ds_read_b128 v[112:115], v251 offset:5376
    s_waitcnt lgkmcnt(8)
    v_mfma_f32_16x16x32_bf16 v[8:11], v[52:55], v[212:215], v[8:11]
    ds_read_b128 v[116:119], v251 offset:5632
    v_mfma_f32_16x16x32_bf16 v[12:15], v[56:59], v[212:215], v[12:15]
    ds_read_b128 v[120:123], v251 offset:5888
    v_mfma_f32_16x16x32_bf16 v[16:19], v[60:63], v[212:215], v[16:19]
    ds_read_b128 v[124:127], v251 offset:6144
    s_waitcnt lgkmcnt(5)
    v_mfma_f32_16x16x32_bf16 v[172:175], v[92:95], v[20:23], 0
    ds_read_b128 v[128:131], v251 offset:10240
    v_mfma_f32_16x16x32_bf16 v[176:179], v[96:99], v[20:23], 0
    ds_read_b128 v[132:135], v251 offset:10496
    v_mfma_f32_16x16x32_bf16 v[180:183], v[100:103], v[20:23], 0
    ds_read_b128 v[136:139], v251 offset:10752
    v_mfma_f32_16x16x32_bf16 v[184:187], v[104:107], v[20:23], 0
    ds_read_b128 v[140:143], v251 offset:11008
    v_sub_f32_e64 v252, 1.0, v253
    v_mfma_f32_16x16x32_bf16 v[168:171], v[88:91], v[20:23], 0
    ds_read_b128 v[144:147], v251 offset:11264
    v_mul_f32_e64 v0, v0, v253
    s_barrier
    s_waitcnt lgkmcnt(5)
    v_mfma_f32_16x16x32_bf16 v[172:175], v[112:115], v[24:27], v[172:175]
    ds_read_b128 v[148:151], v251 offset:15360
    v_mul_f32_e64 v1, v1, v253
    v_mfma_f32_16x16x32_bf16 v[176:179], v[116:119], v[24:27], v[176:179]
    ds_read_b128 v[152:155], v251 offset:15616
    v_mul_f32_e64 v2, v2, v253
    v_mfma_f32_16x16x32_bf16 v[180:183], v[120:123], v[24:27], v[180:183]
    ds_read_b128 v[156:159], v251 offset:15872
    v_mul_f32_e64 v3, v3, v253
    v_mfma_f32_16x16x32_bf16 v[184:187], v[124:127], v[24:27], v[184:187]
    ds_read_b128 v[160:163], v251 offset:16128
    v_mul_f32_e64 v4, v4, v253
    v_mfma_f32_16x16x32_bf16 v[168:171], v[108:111], v[24:27], v[168:171]
    ds_read_b128 v[164:167], v251 offset:16384
    v_mul_f32 v5, v5, v253
    s_waitcnt lgkmcnt(5)
    v_mfma_f32_16x16x32_bf16 v[172:175], v[132:135], v[28:31], v[172:175]
    v_mul_f32 v6, v6, v253
    v_mul_f32 v7, v7, v253
    v_mfma_f32_16x16x32_bf16 v[176:179], v[136:139], v[28:31], v[176:179]
    v_mul_f32 v8, v8, v253
    v_mul_f32 v9, v9, v253
    v_mfma_f32_16x16x32_bf16 v[180:183], v[140:143], v[28:31], v[180:183]
    v_mul_f32 v10, v10, v253
    v_mul_f32 v11, v11, v253
    v_mfma_f32_16x16x32_bf16 v[184:187], v[144:147], v[28:31], v[184:187]
    v_mul_f32 v12, v12, v253
    v_mul_f32 v13, v13, v253
    v_mfma_f32_16x16x32_bf16 v[168:171], v[128:131], v[28:31], v[168:171]
    v_mul_f32 v14, v14, v253
    v_mul_f32_e64 v15, v15, v253
    s_waitcnt lgkmcnt(0)
    v_mfma_f32_16x16x32_bf16 v[172:175], v[152:155], v[32:35], v[172:175]
    v_mul_f32 v16, v16, v253
    v_mul_f32 v17, v17, v253
    v_mfma_f32_16x16x32_bf16 v[176:179], v[156:159], v[32:35], v[176:179]
    v_mul_f32 v18, v18, v253
    v_mul_f32 v19, v19, v253
    v_mfma_f32_16x16x32_bf16 v[180:183], v[160:163], v[32:35], v[180:183]
    v_mfma_f32_16x16x32_bf16 v[184:187], v[164:167], v[32:35], v[184:187]
    v_mfma_f32_16x16x32_bf16 v[168:171], v[148:151], v[32:35], v[168:171]
    v_pk_fma_f32 v[4:5], v[172:173], v[252:253], v[4:5] op_sel_hi:[1,0,1]
    v_pk_fma_f32 v[6:7], v[174:175], v[252:253], v[6:7] op_sel_hi:[1,0,1]
    v_cvt_pk_bf16_f32 v62, v4, v5
    v_cvt_pk_bf16_f32 v63, v6, v7
    ds_write_b64 v36, v[62:63] offset:32
    v_pk_fma_f32 v[8:9], v[176:177], v[252:253], v[8:9] op_sel_hi:[1,0,1]
    v_pk_fma_f32 v[10:11], v[178:179], v[252:253], v[10:11] op_sel_hi:[1,0,1]
    v_cvt_pk_bf16_f32 v64, v8, v9
    v_cvt_pk_bf16_f32 v65, v10, v11
    ds_write_b64 v36, v[64:65] offset:64
    v_pk_fma_f32 v[12:13], v[180:181], v[252:253], v[12:13] op_sel_hi:[1,0,1]
    v_pk_fma_f32 v[14:15], v[182:183], v[252:253], v[14:15] op_sel_hi:[1,0,1]
    v_cvt_pk_bf16_f32 v66, v12, v13
    v_cvt_pk_bf16_f32 v67, v14, v15
    ds_write_b64 v36, v[66:67] offset:96
    v_pk_fma_f32 v[16:17], v[184:185], v[252:253], v[16:17] op_sel_hi:[1,0,1]
    v_pk_fma_f32 v[18:19], v[186:187], v[252:253], v[18:19] op_sel_hi:[1,0,1]
    v_cvt_pk_bf16_f32 v68, v16, v17
    v_cvt_pk_bf16_f32 v69, v18, v19
    ds_write_b64 v36, v[68:69] offset:128
    v_pk_fma_f32 v[0:1], v[168:169], v[252:253], v[0:1] op_sel_hi:[1,0,1]
    v_pk_fma_f32 v[2:3], v[170:171], v[252:253], v[2:3] op_sel_hi:[1,0,1]
    v_cvt_pk_bf16_f32 v60, v0, v1
    v_cvt_pk_bf16_f32 v61, v2, v3
    ds_write_b64 v36, v[60:61] offset:0
    ds_read_b128 v[40:43], v37 offset:0
    ds_read_b128 v[44:47], v37 offset:1056
    ds_read_b128 v[48:51], v37 offset:2112
    s_mov_b32 exec_hi, 0x0fffffff
    s_waitcnt lgkmcnt(2)
    buffer_store_dwordx4 v[40:43], v254, s[36:39], s41 offen
    s_add_u32 s41, s41, 491520
    s_waitcnt lgkmcnt(1)
    buffer_store_dwordx4 v[44:47], v254, s[36:39], s41 offen
    s_add_u32 s41, s41, 491520
    s_mov_b32 exec_hi, 0xff
    s_waitcnt lgkmcnt(0)
    buffer_store_dwordx4 v[48:51], v254, s[36:39], s41 offen

L_exit:
    s_endpgm
L_fix0:
    s_movk_i32 s56, 0
    s_call_b64 s[70:71], S_retry
    ds_read_b128 v[76:79], v248 offset:0
    ds_read_b128 v[80:83], v249 offset:0
    s_waitcnt lgkmcnt(0)
    s_cbranch_scc1 L_go0
    v_max3_u32 v255, v76, v79, v80
    v_max_u32 v255, v255, v83
    v_cmp_eq_u32 vcc, -1, v255
    s_cbranch_vccnz L_fix0
    s_branch L_go0
L_fix1:
    s_movk_i32 s56, 1
    s_call_b64 s[70:71], S_retry
    ds_read_b128 v[84:87], v248 offset:2048
    ds_read_b128 v[88:91], v249 offset:2048
    s_waitcnt lgkmcnt(0)
    s_cbranch_scc1 L_go1
    v_max3_u32 v255, v84, v87, v88
    v_max_u32 v255, v255, v91
    v_cmp_eq_u32 vcc, -1, v255
    s_cbranch_vccnz L_fix1
    s_branch L_go1
L_fix2:
    s_movk_i32 s56, 2
    s_call_b64 s[70:71], S_retry
    ds_read_b128 v[96:99], v248 offset:4096
    ds_read_b128 v[100:103], v249 offset:4096
    s_waitcnt lgkmcnt(0)
    s_cbranch_scc1 L_go2
    v_max3_u32 v255, v96, v99, v100
    v_max_u32 v255, v255, v103
    v_cmp_eq_u32 vcc, -1, v255
    s_cbranch_vccnz L_fix2
    s_branch L_go2
L_fix3:
    s_movk_i32 s56, 3
    s_call_b64 s[70:71], S_retry
    ds_read_b128 v[112:115], v248 offset:6144
    ds_read_b128 v[116:119], v249 offset:6144
    s_waitcnt lgkmcnt(0)
    s_cbranch_scc1 L_go3
    v_max3_u32 v255, v112, v115, v116
    v_max_u32 v255, v255, v119
    v_cmp_eq_u32 vcc, -1, v255
    s_cbranch_vccnz L_fix3
    s_branch L_go3
L_fix4:
    s_movk_i32 s56, 4
    s_call_b64 s[70:71], S_retry
    ds_read_b128 v[128:131], v248 offset:49152
    ds_read_b128 v[132:135], v249 offset:49152
    s_waitcnt lgkmcnt(0)
    s_cbranch_scc1 L_go4
    v_max3_u32 v255, v128, v131, v132
    v_max_u32 v255, v255, v135
    v_cmp_eq_u32 vcc, -1, v255
    s_cbranch_vccnz L_fix4
    s_branch L_go4
L_fix5:
    s_movk_i32 s56, 5
    s_call_b64 s[70:71], S_retry
    ds_read_b128 v[144:147], v248 offset:0
    ds_read_b128 v[148:151], v249 offset:0
    s_waitcnt lgkmcnt(0)
    s_cbranch_scc1 L_go5
    v_max3_u32 v255, v144, v147, v148
    v_max_u32 v255, v255, v151
    v_cmp_eq_u32 vcc, -1, v255
    s_cbranch_vccnz L_fix5
    s_branch L_go5
L_fix6:
    s_movk_i32 s56, 6
    s_call_b64 s[70:71], S_retry
    ds_read_b128 v[160:163], v248 offset:2048
    ds_read_b128 v[164:167], v249 offset:2048
    s_waitcnt lgkmcnt(0)
    s_cbranch_scc1 L_go6
    v_max3_u32 v255, v160, v163, v164
    v_max_u32 v255, v255, v167
    v_cmp_eq_u32 vcc, -1, v255
    s_cbranch_vccnz L_fix6
    s_branch L_go6
L_fix7:
    s_movk_i32 s56, 7
    s_call_b64 s[70:71], S_retry
    ds_read_b128 v[176:179], v248 offset:4096
    ds_read_b128 v[180:183], v249 offset:4096
    s_waitcnt lgkmcnt(0)
    s_cbranch_scc1 L_go7
    v_max3_u32 v255, v176, v179, v180
    v_max_u32 v255, v255, v183
    v_cmp_eq_u32 vcc, -1, v255
    s_cbranch_vccnz L_fix7
    s_branch L_go7
L_fix8:
    s_movk_i32 s56, 8
    s_call_b64 s[70:71], S_retry
    ds_read_b128 v[192:195], v248 offset:6144
    ds_read_b128 v[196:199], v249 offset:6144
    s_waitcnt lgkmcnt(0)
    s_cbranch_scc1 L_go8
    v_max3_u32 v255, v192, v195, v196
    v_max_u32 v255, v255, v199
    v_cmp_eq_u32 vcc, -1, v255
    s_cbranch_vccnz L_fix8
    s_branch L_go8
L_fix9:
    s_movk_i32 s56, 9
    s_call_b64 s[70:71], S_retry
    ds_read_b128 v[208:211], v248 offset:8192
    ds_read_b128 v[212:215], v249 offset:8192
    s_waitcnt lgkmcnt(0)
    s_cbranch_scc1 L_go9
    v_max3_u32 v255, v208, v211, v212
    v_max_u32 v255, v255, v215
    v_cmp_eq_u32 vcc, -1, v255
    s_cbranch_vccnz L_fix9
    s_branch L_go9
S_retry:
    v_lshrrev_b32 v255, 4, v250
    v_lshrrev_b32 v38, 3, v255
    v_mul_u32_u24 v38, 81920, v38
    v_and_b32 v39, 7, v255
    v_lshrrev_b32 v255, 4, v255
    v_xor_b32 v39, v39, v255
    v_lshl_add_u32 v38, v39, 4, v38
    v_xor_b32 v39, 64, v38
    v_add_u32 v39, 654336, v39
    s_mov_b64 s[12:13], s[50:51]
    s_mov_b32 s14, 2621440
    s_mov_b32 s15, 0x20000
    s_add_u32 s60, s56, 4
    s_min_u32 s60, s60, 10
    s_mul_i32 s61, s98, 1280
    s_waitcnt lgkmcnt(0)
L_rt1:
    s_lshl_b32 s72, s56, 11
    s_cmp_lt_u32 s56, 5
    s_cselect_b32 s73, 0, 51200
    s_sub_u32 s72, s72, s73
    s_add_u32 m0, s72, s99
    s_lshl_b32 s72, s56, 7
    s_add_u32 s72, s72, s61
    buffer_load_dwordx4 v38, s[12:15], s72 offen  sc1 lds
    buffer_load_dwordx4 v39, s[12:15], s72 offen offset:1024 sc1 lds
    s_add_u32 s56, s56, 1
    s_cmp_lt_u32 s56, s60
    s_cbranch_scc1 L_rt1
    s_waitcnt vmcnt(0)
    s_sub_u32 s59, s59, 1
    s_cselect_b32 s59, 0, s59
    s_setpc_b64 s[70:71]
L_code_hot:
.section .rodata,"a"
.p2align 6
.amdhsa_kernel gated_mix__sliding_local_dilated__spectral_fnet__prompt_kernel
  .amdhsa_next_free_vgpr 256
  .amdhsa_next_free_sgpr 102
  .amdhsa_accum_offset 256
  .amdhsa_group_segment_fixed_size 0
  .amdhsa_kernarg_size 96
  .amdhsa_user_sgpr_count 2
  .amdhsa_user_sgpr_kernarg_segment_ptr 1
  .amdhsa_system_sgpr_workgroup_id_x 1
.end_amdhsa_kernel
```
